```python
import torch

def _softmax(x, axis=-1):
    return torch.softmax(x, dim=axis)
def _gelu(x):
    return torch.nn.functional.gelu(x, approximate="tanh")
def _silu(x):
    return torch.nn.functional.silu(x)
def _sigmoid(x):
    return torch.sigmoid(x)
def _layernorm(x, axis=-1, eps=1e-5):
    m = x.mean(dim=axis, keepdim=True)
    v = x.var(dim=axis, keepdim=True, unbiased=False)
    return (x - m) / torch.sqrt(v + eps)
def _scatter_add(tgt, idx, src, axis=0):
    return tgt.clone().index_add_(axis, idx, src)
def _segment_sum(src, seg, n):
    out = torch.zeros((n,) + src.shape[1:], dtype=src.dtype)
    return out.index_add_(0, seg, src)
def _pad(x, pw):
    flat = tuple(v for pair in reversed(pw) for v in pair)
    return torch.nn.functional.pad(x, flat)

kernel_name = 'standalone__structured_sparse_n_m__ragged'

def setup_inputs():

    _w = (lambda a: (lambda t: t.to(torch.bfloat16) if t.is_floating_point() else t)(torch.as_tensor(a)))
    B, S, D = 4, 4096, 512
    assert D % 4 == 0, "d_model must be divisible by M=4 for 2:4 sparsity"
    return {
        "x": _w((lambda *s: torch.randn(*s, dtype=torch.bfloat16) * 0.05)(B, S, D)),
        "w": _w((lambda *s: torch.randn(*s, dtype=torch.bfloat16) * 0.05)(D, D)),
        "b": _w((lambda *s: torch.randn(*s, dtype=torch.bfloat16) * 0.05)(D)),
    }

def reference(x, w, b):
    B, S, D = x.shape
    N, M = 2, 4
    G = D // M
    wg = w.reshape(G, M, D)
    mag = torch.abs(wg)
    order = torch.argsort(mag, 1)
    thr = (lambda x, i, axis: torch.take_along_dim(x, i, dim=axis))(mag, order[:, M - N:M - N + 1, :], 1)
    mask = (lambda x, dt: x.to(dt))(mag >= thr, w.dtype)
    wp = (wg * mask).reshape(D, D)
    return torch.einsum("bsd,df->bsf", x, wp) + b
```

```asm
; @launch grid=(256,1,1) block=(512,1,1) lds=163840
.amdgcn_target "amdgcn-amd-amdhsa--gfx950"
.text
.globl standalone__structured_sparse_n_m__ragged_kernel
.p2align 8
.type standalone__structured_sparse_n_m__ragged_kernel,@function
standalone__structured_sparse_n_m__ragged_kernel:
    s_cmp_ge_u32 s2, 256
    s_cbranch_scc1 L_end
    s_load_dwordx4 s[4:7], s[0:1], 0
    s_load_dwordx2 s[16:17], s[0:1], 16
    s_load_dwordx2 s[20:21], s[0:1], 24
    s_getpc_b64 s[30:31]
L_pc:
    v_lshlrev_b32 v50, 7, v0
    v_min_u32 v50, L_end-L_pc, v50
    v_mov_b32 v51, s31
    v_add_co_u32 v50, vcc, s30, v50
    v_lshrrev_b32 v44, 6, v0
    v_and_b32 v32, 63, v0
    v_addc_co_u32 v51, vcc, 0, v51, vcc
    global_load_dword v52, v[50:51], off
    v_readfirstlane_b32 s24, v44
    s_lshr_b32 s30, s2, 3
    s_and_b32 s31, s30, 3
    v_and_b32 v44, 15, v32
    v_lshrrev_b32 v45, 4, v32
    s_lshl_b32 s27, s31, 8
    s_and_b32 s25, s24, 3
    s_lshr_b32 s26, s24, 2
    s_lshl_b32 s29, s25, 2
    s_add_u32 s29, s29, s26
    s_lshl_b32 s29, s29, 1
    v_and_b32 v49, 2, v45
    v_add_u32 v49, v49, v45
    v_add_u32 v49, s29, v49
    v_lshlrev_b32 v33, 12, v49
    v_lshl_add_u32 v33, v44, 4, v33
    v_add_u32 v33, s27, v33
    s_lshr_b32 s30, s30, 2
    s_and_b32 s3, s30, 3
    s_lshl_b32 s40, s3, 17
    s_xor_b32 s41, s40, 0x20000
    s_xor_b32 s42, s40, 0x40000
    s_xor_b32 s43, s40, 0x60000
    s_mov_b32 s14, 0x80000
    s_mov_b32 s15, 0x00020000
    s_mov_b32 s28, 0x76543210
    s_cmp_eq_u32 s31, 1
    s_cselect_b32 s28, 0x32107654, s28
    s_cmp_eq_u32 s31, 3
    s_cselect_b32 s28, 0x32107654, s28
    s_and_b32 s29, s2, 7
    s_lshl_b32 s30, s30, 3
    s_add_u32 s30, s30, s29
    s_lshl_b32 s30, s30, 3
    s_waitcnt lgkmcnt(0)
    s_mov_b32 s12, s6
    s_mov_b32 s13, s7
    buffer_load_dwordx4 v[224:227], v33, s[12:15], s40 offen offset:0
    buffer_load_dwordx4 v[228:231], v33, s[12:15], s40 offen offset:1024
    buffer_load_dwordx4 v[232:235], v33, s[12:15], s40 offen offset:2048
    buffer_load_dwordx4 v[236:239], v33, s[12:15], s40 offen offset:3072
    s_barrier
    buffer_load_dwordx4 v[240:243], v33, s[12:15], s41 offen offset:0
    buffer_load_dwordx4 v[244:247], v33, s[12:15], s41 offen offset:1024
    buffer_load_dwordx4 v[248:251], v33, s[12:15], s41 offen offset:2048
    buffer_load_dwordx4 v[252:255], v33, s[12:15], s41 offen offset:3072
    s_mov_b32 s8, s4
    s_mov_b32 s9, s5
    s_mov_b32 s10, 0x1000000
    s_mov_b32 s11, 0x00020000
    s_mov_b32 s22, 0x1000000
    s_mov_b32 s23, 0x00020000
    s_mov_b32 s18, 0x400
    s_mov_b32 s19, 0x00020000
    s_bfe_u32 s32, s28, 0x30000
    s_add_u32 s32, s32, s30
    s_lshl_b32 s32, s32, 15
    s_bfe_u32 s33, s28, 0x30004
    s_add_u32 s33, s33, s30
    s_lshl_b32 s33, s33, 15
    s_bfe_u32 s34, s28, 0x30008
    s_add_u32 s34, s34, s30
    s_lshl_b32 s34, s34, 15
    s_bfe_u32 s35, s28, 0x3000c
    s_add_u32 s35, s35, s30
    s_lshl_b32 s35, s35, 15
    s_bfe_u32 s36, s28, 0x30010
    s_add_u32 s36, s36, s30
    s_lshl_b32 s36, s36, 15
    s_bfe_u32 s37, s28, 0x30014
    s_add_u32 s37, s37, s30
    s_lshl_b32 s37, s37, 15
    s_bfe_u32 s38, s28, 0x30018
    s_add_u32 s38, s38, s30
    s_lshl_b32 s38, s38, 15
    s_bfe_u32 s39, s28, 0x3001c
    s_add_u32 s39, s39, s30
    s_lshl_b32 s39, s39, 15
    s_lshl_b32 s28, s25, 12
    s_lshl_b32 s3, s3, 4
    s_lshl_b32 s29, s25, 2
    s_or_b32 s29, s29, s3
    v_xor_b32 v46, s29, v32
    v_lshlrev_b32 v46, 4, v46
    v_add_u32 v12, s28, v46
    v_xor_b32 v13, 16, v12
    v_xor_b32 v14, 32, v12
    v_xor_b32 v15, 48, v12
    v_lshlrev_b32 v47, 10, v49
    v_lshl_add_u32 v47, v44, 4, v47
    v_add_u32 v1, 0x18000, v47
    v_xor_b32 v2, 64, v1
    v_xor_b32 v3, 128, v1
    v_xor_b32 v4, 192, v1
    v_mov_b32 v0, 0x80008000
    v_xor_b32 v46, v45, v44
    v_lshlrev_b32 v46, 4, v46
    v_lshl_add_u32 v8, v44, 10, v46
    v_xor_b32 v9, 64, v8
    v_xor_b32 v10, 128, v8
    v_xor_b32 v11, 192, v8
    v_lshrrev_b32 v46, 2, v44
    v_lshl_add_u32 v48, v45, 3, v46
    v_lshlrev_b32 v5, 8, v48
    v_xor_b32 v48, s25, v46
    v_lshl_add_u32 v5, v48, 6, v5
    v_and_b32 v48, 3, v32
    v_lshl_add_u32 v5, v48, 4, v5
    v_and_b32 v47, 1, v45
    v_lshl_add_u32 v5, v47, 3, v5
    v_add_u32 v5, 0x18000, v5
    v_xor_b32 v95, 8, v5
    s_lshl_b32 s29, s25, 6
    s_add_u32 s29, s29, s27
    v_lshlrev_b32 v46, 4, v46
    v_add_u32 v46, s29, v46
    v_lshl_add_u32 v34, v48, 1, v46
    v_and_b32 v47, 1, v32
    v_lshl_add_u32 v46, v47, 3, v46
    v_and_b32 v48, 2, v32
    v_lshl_add_u32 v46, v48, 1, v46
    v_lshl_add_u32 v7, v45, 12, v46
    v_sub_u32 v47, 0, v47
    v_and_b32 v47, 0x06060606, v47
    v_xor_b32 v6, 0x05040100, v47
    s_cmp_lg_u32 s26, 0
    s_cbranch_scc1 L_B
    s_setprio 3
    s_waitcnt vmcnt(4)
    v_or_b32 v16, v0, v224
    v_or_b32 v17, v0, v228
    v_or_b32 v18, v0, v232
    v_or_b32 v19, v0, v236
    v_pk_max_u16 v20, v16, v17
    v_pk_min_u16 v21, v16, v17
    v_pk_max_u16 v22, v18, v19
    v_pk_min_u16 v23, v18, v19
    v_pk_min_u16 v20, v20, v22
    v_pk_max_u16 v21, v21, v23
    v_pk_max_u16 v20, v20, v21
    v_xor_b32 v20, v0, v20
    v_sub_u32 v16, v16, v20
    v_sub_u32 v17, v17, v20
    v_sub_u32 v18, v18, v20
    v_sub_u32 v19, v19, v20
    v_pk_ashrrev_i16 v16, 15, v16 op_sel_hi:[0,1]
    v_pk_ashrrev_i16 v17, 15, v17 op_sel_hi:[0,1]
    v_pk_ashrrev_i16 v18, 15, v18 op_sel_hi:[0,1]
    v_pk_ashrrev_i16 v19, 15, v19 op_sel_hi:[0,1]
    v_and_b32 v224, v16, v224
    v_and_b32 v228, v17, v228
    v_and_b32 v232, v18, v232
    v_and_b32 v236, v19, v236
    v_or_b32 v16, v0, v225
    v_or_b32 v17, v0, v229
    v_or_b32 v18, v0, v233
    v_or_b32 v19, v0, v237
    v_pk_max_u16 v20, v16, v17
    v_pk_min_u16 v21, v16, v17
    v_pk_max_u16 v22, v18, v19
    v_pk_min_u16 v23, v18, v19
    v_pk_min_u16 v20, v20, v22
    v_pk_max_u16 v21, v21, v23
    v_pk_max_u16 v20, v20, v21
    v_xor_b32 v20, v0, v20
    v_sub_u32 v16, v16, v20
    v_sub_u32 v17, v17, v20
    v_sub_u32 v18, v18, v20
    v_sub_u32 v19, v19, v20
    v_pk_ashrrev_i16 v16, 15, v16 op_sel_hi:[0,1]
    v_pk_ashrrev_i16 v17, 15, v17 op_sel_hi:[0,1]
    v_pk_ashrrev_i16 v18, 15, v18 op_sel_hi:[0,1]
    v_pk_ashrrev_i16 v19, 15, v19 op_sel_hi:[0,1]
    v_and_b32 v225, v16, v225
    v_and_b32 v229, v17, v229
    v_and_b32 v233, v18, v233
    v_and_b32 v237, v19, v237
    v_or_b32 v16, v0, v226
    v_or_b32 v17, v0, v230
    v_or_b32 v18, v0, v234
    v_or_b32 v19, v0, v238
    v_pk_max_u16 v20, v16, v17
    v_pk_min_u16 v21, v16, v17
    v_pk_max_u16 v22, v18, v19
    v_pk_min_u16 v23, v18, v19
    v_pk_min_u16 v20, v20, v22
    v_pk_max_u16 v21, v21, v23
    v_pk_max_u16 v20, v20, v21
    v_xor_b32 v20, v0, v20
    v_sub_u32 v16, v16, v20
    v_sub_u32 v17, v17, v20
    v_sub_u32 v18, v18, v20
    v_sub_u32 v19, v19, v20
    v_pk_ashrrev_i16 v16, 15, v16 op_sel_hi:[0,1]
    v_pk_ashrrev_i16 v17, 15, v17 op_sel_hi:[0,1]
    v_pk_ashrrev_i16 v18, 15, v18 op_sel_hi:[0,1]
    v_pk_ashrrev_i16 v19, 15, v19 op_sel_hi:[0,1]
    v_and_b32 v226, v16, v226
    v_and_b32 v230, v17, v230
    v_and_b32 v234, v18, v234
    v_and_b32 v238, v19, v238
    v_or_b32 v16, v0, v227
    v_or_b32 v17, v0, v231
    v_or_b32 v18, v0, v235
    v_or_b32 v19, v0, v239
    v_pk_max_u16 v20, v16, v17
    v_pk_min_u16 v21, v16, v17
    v_pk_max_u16 v22, v18, v19
    v_pk_min_u16 v23, v18, v19
    v_pk_min_u16 v20, v20, v22
    v_pk_max_u16 v21, v21, v23
    v_pk_max_u16 v20, v20, v21
    v_xor_b32 v20, v0, v20
    v_sub_u32 v16, v16, v20
    v_sub_u32 v17, v17, v20
    v_sub_u32 v18, v18, v20
    v_sub_u32 v19, v19, v20
    v_pk_ashrrev_i16 v16, 15, v16 op_sel_hi:[0,1]
    v_pk_ashrrev_i16 v17, 15, v17 op_sel_hi:[0,1]
    v_pk_ashrrev_i16 v18, 15, v18 op_sel_hi:[0,1]
    v_pk_ashrrev_i16 v19, 15, v19 op_sel_hi:[0,1]
    v_and_b32 v227, v16, v227
    v_and_b32 v231, v17, v231
    v_and_b32 v235, v18, v235
    v_and_b32 v239, v19, v239
    s_setprio 1
    ds_write_b128 v1, v[224:227] offset:0
    ds_write_b128 v2, v[228:231] offset:256
    ds_write_b128 v3, v[232:235] offset:512
    ds_write_b128 v4, v[236:239] offset:768
    buffer_load_ushort v24, v34, s[16:19], 0 offen
    buffer_load_ushort v28, v34, s[16:19], 0 offen offset:8
    buffer_load_dwordx4 v[64:67], v33, s[12:15], s42 offen offset:0
    buffer_load_dwordx4 v[68:71], v33, s[12:15], s42 offen offset:1024
    buffer_load_dwordx4 v[72:75], v33, s[12:15], s42 offen offset:2048
    buffer_load_dwordx4 v[76:79], v33, s[12:15], s42 offen offset:3072
    v_xor_b32 v35, 0x2000, v33
    buffer_load_dwordx4 v[96:99], v35, s[12:15], s42 offen offset:0
    buffer_load_dwordx4 v[100:103], v35, s[12:15], s42 offen offset:1024
    buffer_load_dwordx4 v[104:107], v35, s[12:15], s42 offen offset:2048
    buffer_load_dwordx4 v[108:111], v35, s[12:15], s42 offen offset:3072
    s_waitcnt vmcnt(10)
    v_or_b32 v16, v0, v240
    v_or_b32 v17, v0, v244
    v_or_b32 v18, v0, v248
    v_or_b32 v19, v0, v252
    v_pk_max_u16 v20, v16, v17
    v_pk_min_u16 v21, v16, v17
    v_pk_max_u16 v22, v18, v19
    v_pk_min_u16 v23, v18, v19
    v_pk_min_u16 v20, v20, v22
    v_pk_max_u16 v21, v21, v23
    v_pk_max_u16 v20, v20, v21
    v_xor_b32 v20, v0, v20
    v_sub_u32 v16, v16, v20
    v_sub_u32 v17, v17, v20
    v_sub_u32 v18, v18, v20
    v_sub_u32 v19, v19, v20
    v_pk_ashrrev_i16 v16, 15, v16 op_sel_hi:[0,1]
    v_pk_ashrrev_i16 v17, 15, v17 op_sel_hi:[0,1]
    v_pk_ashrrev_i16 v18, 15, v18 op_sel_hi:[0,1]
    v_pk_ashrrev_i16 v19, 15, v19 op_sel_hi:[0,1]
    v_and_b32 v240, v16, v240
    v_and_b32 v244, v17, v244
    v_and_b32 v248, v18, v248
    v_and_b32 v252, v19, v252
    v_or_b32 v16, v0, v241
    v_or_b32 v17, v0, v245
    v_or_b32 v18, v0, v249
    v_or_b32 v19, v0, v253
    v_pk_max_u16 v20, v16, v17
    v_pk_min_u16 v21, v16, v17
    v_pk_max_u16 v22, v18, v19
    v_pk_min_u16 v23, v18, v19
    v_pk_min_u16 v20, v20, v22
    v_pk_max_u16 v21, v21, v23
    v_pk_max_u16 v20, v20, v21
    v_xor_b32 v20, v0, v20
    v_sub_u32 v16, v16, v20
    v_sub_u32 v17, v17, v20
    v_sub_u32 v18, v18, v20
    v_sub_u32 v19, v19, v20
    v_pk_ashrrev_i16 v16, 15, v16 op_sel_hi:[0,1]
    v_pk_ashrrev_i16 v17, 15, v17 op_sel_hi:[0,1]
    v_pk_ashrrev_i16 v18, 15, v18 op_sel_hi:[0,1]
    v_pk_ashrrev_i16 v19, 15, v19 op_sel_hi:[0,1]
    v_and_b32 v241, v16, v241
    v_and_b32 v245, v17, v245
    v_and_b32 v249, v18, v249
    v_and_b32 v253, v19, v253
    v_or_b32 v16, v0, v242
    v_or_b32 v17, v0, v246
    v_or_b32 v18, v0, v250
    v_or_b32 v19, v0, v254
    v_pk_max_u16 v20, v16, v17
    v_pk_min_u16 v21, v16, v17
    v_pk_max_u16 v22, v18, v19
    v_pk_min_u16 v23, v18, v19
    v_pk_min_u16 v20, v20, v22
    v_pk_max_u16 v21, v21, v23
    v_pk_max_u16 v20, v20, v21
    v_xor_b32 v20, v0, v20
    v_sub_u32 v16, v16, v20
    v_sub_u32 v17, v17, v20
    v_sub_u32 v18, v18, v20
    v_sub_u32 v19, v19, v20
    v_pk_ashrrev_i16 v16, 15, v16 op_sel_hi:[0,1]
    v_pk_ashrrev_i16 v17, 15, v17 op_sel_hi:[0,1]
    v_pk_ashrrev_i16 v18, 15, v18 op_sel_hi:[0,1]
    v_pk_ashrrev_i16 v19, 15, v19 op_sel_hi:[0,1]
    v_and_b32 v242, v16, v242
    v_and_b32 v246, v17, v246
    v_and_b32 v250, v18, v250
    v_and_b32 v254, v19, v254
    v_or_b32 v16, v0, v243
    v_or_b32 v17, v0, v247
    v_or_b32 v18, v0, v251
    v_or_b32 v19, v0, v255
    v_pk_max_u16 v20, v16, v17
    v_pk_min_u16 v21, v16, v17
    v_pk_max_u16 v22, v18, v19
    v_pk_min_u16 v23, v18, v19
    v_pk_min_u16 v20, v20, v22
    v_pk_max_u16 v21, v21, v23
    v_pk_max_u16 v20, v20, v21
    v_xor_b32 v20, v0, v20
    v_sub_u32 v16, v16, v20
    v_sub_u32 v17, v17, v20
    v_sub_u32 v18, v18, v20
    v_sub_u32 v19, v19, v20
    v_pk_ashrrev_i16 v16, 15, v16 op_sel_hi:[0,1]
    v_pk_ashrrev_i16 v17, 15, v17 op_sel_hi:[0,1]
    v_pk_ashrrev_i16 v18, 15, v18 op_sel_hi:[0,1]
    v_pk_ashrrev_i16 v19, 15, v19 op_sel_hi:[0,1]
    v_and_b32 v243, v16, v243
    v_and_b32 v247, v17, v247
    v_and_b32 v251, v18, v251
    v_and_b32 v255, v19, v255
    s_waitcnt lgkmcnt(0)
    s_barrier
    ds_read_b64_tr_b16 v[128:129], v5 offset:0
    ds_read_b64_tr_b16 v[130:131], v5 offset:1024
    ds_read_b64_tr_b16 v[132:133], v95 offset:0
    ds_read_b64_tr_b16 v[134:135], v95 offset:1024
    ds_read_b64_tr_b16 v[136:137], v5 offset:8192
    ds_read_b64_tr_b16 v[138:139], v5 offset:9216
    ds_read_b64_tr_b16 v[140:141], v95 offset:8192
    ds_read_b64_tr_b16 v[142:143], v95 offset:9216
    ds_read_b64_tr_b16 v[144:145], v5 offset:16384
    ds_read_b64_tr_b16 v[146:147], v5 offset:17408
    ds_read_b64_tr_b16 v[148:149], v95 offset:16384
    ds_read_b64_tr_b16 v[150:151], v95 offset:17408
    ds_read_b64_tr_b16 v[152:153], v5 offset:24576
    ds_read_b64_tr_b16 v[154:155], v5 offset:25600
    ds_read_b64_tr_b16 v[156:157], v95 offset:24576
    ds_read_b64_tr_b16 v[158:159], v95 offset:25600
    ds_write_b128 v1, v[240:243] offset:32768
    ds_write_b128 v2, v[244:247] offset:33024
    ds_write_b128 v3, v[248:251] offset:33280
    ds_write_b128 v4, v[252:255] offset:33536
    s_add_u32 m0, s28, 0x0
    s_nop 0
    buffer_load_dwordx4 v12, s[8:11], s32 offen offset:0  lds
    buffer_load_dwordx4 v13, s[8:11], s32 offen offset:1024  lds
    buffer_load_dwordx4 v14, s[8:11], s32 offen offset:2048  lds
    buffer_load_dwordx4 v15, s[8:11], s32 offen offset:3072  lds
    s_waitcnt vmcnt(8)
    v_or_b32 v16, v0, v64
    v_or_b32 v17, v0, v68
    v_or_b32 v18, v0, v72
    v_or_b32 v19, v0, v76
    v_pk_max_u16 v20, v16, v17
    v_pk_min_u16 v21, v16, v17
    v_pk_max_u16 v22, v18, v19
    v_pk_min_u16 v23, v18, v19
    v_pk_min_u16 v20, v20, v22
    v_pk_max_u16 v21, v21, v23
    v_pk_max_u16 v20, v20, v21
    v_xor_b32 v20, v0, v20
    v_sub_u32 v16, v16, v20
    v_sub_u32 v17, v17, v20
    v_sub_u32 v18, v18, v20
    v_sub_u32 v19, v19, v20
    v_pk_ashrrev_i16 v16, 15, v16 op_sel_hi:[0,1]
    v_pk_ashrrev_i16 v17, 15, v17 op_sel_hi:[0,1]
    v_pk_ashrrev_i16 v18, 15, v18 op_sel_hi:[0,1]
    v_pk_ashrrev_i16 v19, 15, v19 op_sel_hi:[0,1]
    v_and_b32 v64, v16, v64
    v_and_b32 v68, v17, v68
    v_and_b32 v72, v18, v72
    v_and_b32 v76, v19, v76
    v_or_b32 v16, v0, v65
    v_or_b32 v17, v0, v69
    v_or_b32 v18, v0, v73
    v_or_b32 v19, v0, v77
    v_pk_max_u16 v20, v16, v17
    v_pk_min_u16 v21, v16, v17
    v_pk_max_u16 v22, v18, v19
    v_pk_min_u16 v23, v18, v19
    v_pk_min_u16 v20, v20, v22
    v_pk_max_u16 v21, v21, v23
    v_pk_max_u16 v20, v20, v21
    v_xor_b32 v20, v0, v20
    v_sub_u32 v16, v16, v20
    v_sub_u32 v17, v17, v20
    v_sub_u32 v18, v18, v20
    v_sub_u32 v19, v19, v20
    v_pk_ashrrev_i16 v16, 15, v16 op_sel_hi:[0,1]
    v_pk_ashrrev_i16 v17, 15, v17 op_sel_hi:[0,1]
    v_pk_ashrrev_i16 v18, 15, v18 op_sel_hi:[0,1]
    v_pk_ashrrev_i16 v19, 15, v19 op_sel_hi:[0,1]
    v_and_b32 v65, v16, v65
    v_and_b32 v69, v17, v69
    v_and_b32 v73, v18, v73
    v_and_b32 v77, v19, v77
    v_or_b32 v16, v0, v66
    v_or_b32 v17, v0, v70
    v_or_b32 v18, v0, v74
    v_or_b32 v19, v0, v78
    v_pk_max_u16 v20, v16, v17
    v_pk_min_u16 v21, v16, v17
    v_pk_max_u16 v22, v18, v19
    v_pk_min_u16 v23, v18, v19
    v_pk_min_u16 v20, v20, v22
    v_pk_max_u16 v21, v21, v23
    v_pk_max_u16 v20, v20, v21
    v_xor_b32 v20, v0, v20
    v_sub_u32 v16, v16, v20
    v_sub_u32 v17, v17, v20
    v_sub_u32 v18, v18, v20
    v_sub_u32 v19, v19, v20
    v_pk_ashrrev_i16 v16, 15, v16 op_sel_hi:[0,1]
    v_pk_ashrrev_i16 v17, 15, v17 op_sel_hi:[0,1]
    v_pk_ashrrev_i16 v18, 15, v18 op_sel_hi:[0,1]
    v_pk_ashrrev_i16 v19, 15, v19 op_sel_hi:[0,1]
    v_and_b32 v66, v16, v66
    v_and_b32 v70, v17, v70
    v_and_b32 v74, v18, v74
    v_and_b32 v78, v19, v78
    v_or_b32 v16, v0, v67
    v_or_b32 v17, v0, v71
    v_or_b32 v18, v0, v75
    v_or_b32 v19, v0, v79
    v_pk_max_u16 v20, v16, v17
    v_pk_min_u16 v21, v16, v17
    v_pk_max_u16 v22, v18, v19
    v_pk_min_u16 v23, v18, v19
    v_pk_min_u16 v20, v20, v22
    v_pk_max_u16 v21, v21, v23
    v_pk_max_u16 v20, v20, v21
    v_xor_b32 v20, v0, v20
    v_sub_u32 v16, v16, v20
    v_sub_u32 v17, v17, v20
    v_sub_u32 v18, v18, v20
    v_sub_u32 v19, v19, v20
    v_pk_ashrrev_i16 v16, 15, v16 op_sel_hi:[0,1]
    v_pk_ashrrev_i16 v17, 15, v17 op_sel_hi:[0,1]
    v_pk_ashrrev_i16 v18, 15, v18 op_sel_hi:[0,1]
    v_pk_ashrrev_i16 v19, 15, v19 op_sel_hi:[0,1]
    v_and_b32 v67, v16, v67
    v_and_b32 v71, v17, v71
    v_and_b32 v75, v18, v75
    v_and_b32 v79, v19, v79
    v_lshlrev_b32 v27, 16, v24
    v_lshlrev_b32 v26, 16, v24
    v_lshlrev_b32 v25, 16, v24
    v_lshlrev_b32 v24, 16, v24
    v_lshlrev_b32 v31, 16, v28
    v_lshlrev_b32 v30, 16, v28
    v_lshlrev_b32 v29, 16, v28
    v_lshlrev_b32 v28, 16, v28
    s_waitcnt lgkmcnt(0)
    s_barrier
    ds_read_b64_tr_b16 v[160:161], v5 offset:32768
    ds_read_b64_tr_b16 v[162:163], v5 offset:33792
    ds_read_b64_tr_b16 v[164:165], v95 offset:32768
    ds_read_b64_tr_b16 v[166:167], v95 offset:33792
    ds_read_b64_tr_b16 v[168:169], v5 offset:40960
    ds_read_b64_tr_b16 v[170:171], v5 offset:41984
    ds_read_b64_tr_b16 v[172:173], v95 offset:40960
    ds_read_b64_tr_b16 v[174:175], v95 offset:41984
    ds_read_b64_tr_b16 v[176:177], v5 offset:49152
    ds_read_b64_tr_b16 v[178:179], v5 offset:50176
    ds_read_b64_tr_b16 v[180:181], v95 offset:49152
    ds_read_b64_tr_b16 v[182:183], v95 offset:50176
    ds_read_b64_tr_b16 v[184:185], v5 offset:57344
    ds_read_b64_tr_b16 v[186:187], v5 offset:58368
    ds_read_b64_tr_b16 v[188:189], v95 offset:57344
    ds_read_b64_tr_b16 v[190:191], v95 offset:58368
    ds_write_b128 v1, v[64:67] offset:0
    ds_write_b128 v2, v[68:71] offset:256
    ds_write_b128 v3, v[72:75] offset:512
    ds_write_b128 v4, v[76:79] offset:768
    s_waitcnt lgkmcnt(4)
    s_barrier
    s_setprio 3
    s_waitcnt vmcnt(4)
    v_or_b32 v16, v0, v96
    v_or_b32 v17, v0, v100
    v_or_b32 v18, v0, v104
    v_or_b32 v19, v0, v108
    v_pk_max_u16 v20, v16, v17
    v_pk_min_u16 v21, v16, v17
    v_pk_max_u16 v22, v18, v19
    v_pk_min_u16 v23, v18, v19
    v_pk_min_u16 v20, v20, v22
    v_pk_max_u16 v21, v21, v23
    v_pk_max_u16 v20, v20, v21
    v_xor_b32 v20, v0, v20
    v_sub_u32 v16, v16, v20
    v_sub_u32 v17, v17, v20
    v_sub_u32 v18, v18, v20
    v_sub_u32 v19, v19, v20
    v_pk_ashrrev_i16 v16, 15, v16 op_sel_hi:[0,1]
    v_pk_ashrrev_i16 v17, 15, v17 op_sel_hi:[0,1]
    v_pk_ashrrev_i16 v18, 15, v18 op_sel_hi:[0,1]
    v_pk_ashrrev_i16 v19, 15, v19 op_sel_hi:[0,1]
    v_and_b32 v96, v16, v96
    v_and_b32 v100, v17, v100
    v_and_b32 v104, v18, v104
    v_and_b32 v108, v19, v108
    v_or_b32 v16, v0, v97
    v_or_b32 v17, v0, v101
    v_or_b32 v18, v0, v105
    v_or_b32 v19, v0, v109
    v_pk_max_u16 v20, v16, v17
    v_pk_min_u16 v21, v16, v17
    v_pk_max_u16 v22, v18, v19
    v_pk_min_u16 v23, v18, v19
    v_pk_min_u16 v20, v20, v22
    v_pk_max_u16 v21, v21, v23
    v_pk_max_u16 v20, v20, v21
    v_xor_b32 v20, v0, v20
    v_sub_u32 v16, v16, v20
    v_sub_u32 v17, v17, v20
    v_sub_u32 v18, v18, v20
    v_sub_u32 v19, v19, v20
    v_pk_ashrrev_i16 v16, 15, v16 op_sel_hi:[0,1]
    v_pk_ashrrev_i16 v17, 15, v17 op_sel_hi:[0,1]
    v_pk_ashrrev_i16 v18, 15, v18 op_sel_hi:[0,1]
    v_pk_ashrrev_i16 v19, 15, v19 op_sel_hi:[0,1]
    v_and_b32 v97, v16, v97
    v_and_b32 v101, v17, v101
    v_and_b32 v105, v18, v105
    v_and_b32 v109, v19, v109
    v_or_b32 v16, v0, v98
    v_or_b32 v17, v0, v102
    v_or_b32 v18, v0, v106
    v_or_b32 v19, v0, v110
    v_pk_max_u16 v20, v16, v17
    v_pk_min_u16 v21, v16, v17
    v_pk_max_u16 v22, v18, v19
    v_pk_min_u16 v23, v18, v19
    v_pk_min_u16 v20, v20, v22
    v_pk_max_u16 v21, v21, v23
    v_pk_max_u16 v20, v20, v21
    v_xor_b32 v20, v0, v20
    v_sub_u32 v16, v16, v20
    v_sub_u32 v17, v17, v20
    v_sub_u32 v18, v18, v20
    v_sub_u32 v19, v19, v20
    v_pk_ashrrev_i16 v16, 15, v16 op_sel_hi:[0,1]
    v_pk_ashrrev_i16 v17, 15, v17 op_sel_hi:[0,1]
    v_pk_ashrrev_i16 v18, 15, v18 op_sel_hi:[0,1]
    v_pk_ashrrev_i16 v19, 15, v19 op_sel_hi:[0,1]
    v_and_b32 v98, v16, v98
    v_and_b32 v102, v17, v102
    v_and_b32 v106, v18, v106
    v_and_b32 v110, v19, v110
    v_or_b32 v16, v0, v99
    v_or_b32 v17, v0, v103
    v_or_b32 v18, v0, v107
    v_or_b32 v19, v0, v111
    v_pk_max_u16 v20, v16, v17
    v_pk_min_u16 v21, v16, v17
    v_pk_max_u16 v22, v18, v19
    v_pk_min_u16 v23, v18, v19
    v_pk_min_u16 v20, v20, v22
    v_pk_max_u16 v21, v21, v23
    v_pk_max_u16 v20, v20, v21
    v_xor_b32 v20, v0, v20
    v_sub_u32 v16, v16, v20
    v_sub_u32 v17, v17, v20
    v_sub_u32 v18, v18, v20
    v_sub_u32 v19, v19, v20
    v_pk_ashrrev_i16 v16, 15, v16 op_sel_hi:[0,1]
    v_pk_ashrrev_i16 v17, 15, v17 op_sel_hi:[0,1]
    v_pk_ashrrev_i16 v18, 15, v18 op_sel_hi:[0,1]
    v_pk_ashrrev_i16 v19, 15, v19 op_sel_hi:[0,1]
    v_and_b32 v99, v16, v99
    v_and_b32 v103, v17, v103
    v_and_b32 v107, v18, v107
    v_and_b32 v111, v19, v111
    v_add_u32 v1, 0x800, v1
    v_add_u32 v2, 0x800, v2
    v_add_u32 v3, 0x800, v3
    v_add_u32 v4, 0x800, v4
    ds_write2_b64 v1, v[96:97], v[98:99] offset0:1 offset1:0
    ds_write2_b64 v2, v[100:101], v[102:103] offset0:33 offset1:32
    ds_write2_b64 v3, v[104:105], v[106:107] offset0:65 offset1:64
    ds_write2_b64 v4, v[108:109], v[110:111] offset0:97 offset1:96
    s_add_u32 m0, s28, 0x8000
    s_nop 0
    buffer_load_dwordx4 v12, s[8:11], s33 offen offset:0  lds
    buffer_load_dwordx4 v13, s[8:11], s33 offen offset:1024  lds
    buffer_load_dwordx4 v14, s[8:11], s33 offen offset:2048  lds
    buffer_load_dwordx4 v15, s[8:11], s33 offen offset:3072  lds
    s_waitcnt vmcnt(4) lgkmcnt(0)
    s_setprio 2
    s_barrier
    ds_read_b128 v[32:35], v8 offset:0
    ds_read_b128 v[36:39], v8 offset:16384
    ds_read_b128 v[40:43], v9 offset:0
    ds_read_b128 v[44:47], v9 offset:16384
    ds_read_b128 v[48:51], v10 offset:0
    ds_read_b128 v[52:55], v10 offset:16384
    ds_read_b128 v[56:59], v11 offset:0
    ds_read_b128 v[60:63], v11 offset:16384
    s_waitcnt lgkmcnt(6)
    v_mfma_f32_16x16x32_bf16 v[96:99], v[32:35], v[128:131], v[24:27]
    ds_read_b64_tr_b16 v[192:193], v5 offset:0
    ds_read_b64_tr_b16 v[194:195], v5 offset:1024
    v_mfma_f32_16x16x32_bf16 v[100:103], v[32:35], v[132:135], v[28:31]
    ds_read_b128 v[32:35], v8 offset:256
    v_mfma_f32_16x16x32_bf16 v[104:107], v[36:39], v[128:131], v[24:27]
    ds_read_b64_tr_b16 v[196:197], v95 offset:0
    ds_read_b64_tr_b16 v[198:199], v95 offset:1024
    v_mfma_f32_16x16x32_bf16 v[108:111], v[36:39], v[132:135], v[28:31]
    ds_read_b128 v[36:39], v8 offset:16640
    s_waitcnt lgkmcnt(10)
    v_mfma_f32_16x16x32_bf16 v[96:99], v[40:43], v[136:139], v[96:99]
    ds_read_b64_tr_b16 v[200:201], v5 offset:8192
    ds_read_b64_tr_b16 v[202:203], v5 offset:9216
    v_mfma_f32_16x16x32_bf16 v[100:103], v[40:43], v[140:143], v[100:103]
    ds_read_b128 v[40:43], v9 offset:256
    v_mfma_f32_16x16x32_bf16 v[104:107], v[44:47], v[136:139], v[104:107]
    ds_read_b64_tr_b16 v[204:205], v95 offset:8192
    ds_read_b64_tr_b16 v[206:207], v95 offset:9216
    v_mfma_f32_16x16x32_bf16 v[108:111], v[44:47], v[140:143], v[108:111]
    ds_read_b128 v[44:47], v9 offset:16640
    s_waitcnt lgkmcnt(14)
    v_mfma_f32_16x16x32_bf16 v[96:99], v[48:51], v[144:147], v[96:99]
    ds_read_b64_tr_b16 v[208:209], v5 offset:16384
    ds_read_b64_tr_b16 v[210:211], v5 offset:17408
    v_mfma_f32_16x16x32_bf16 v[100:103], v[48:51], v[148:151], v[100:103]
    ds_read_b128 v[48:51], v10 offset:256
    v_mfma_f32_16x16x32_bf16 v[104:107], v[52:55], v[144:147], v[104:107]
    ds_read_b64_tr_b16 v[212:213], v95 offset:16384
    ds_read_b64_tr_b16 v[214:215], v95 offset:17408
    v_mfma_f32_16x16x32_bf16 v[108:111], v[52:55], v[148:151], v[108:111]
    ds_read_b128 v[52:55], v10 offset:16640
    s_waitcnt lgkmcnt(14)
    v_mfma_f32_16x16x32_bf16 v[96:99], v[56:59], v[152:155], v[96:99]
    ds_read_b64_tr_b16 v[216:217], v5 offset:24576
    ds_read_b64_tr_b16 v[218:219], v5 offset:25600
    v_mfma_f32_16x16x32_bf16 v[100:103], v[56:59], v[156:159], v[100:103]
    ds_read_b128 v[56:59], v11 offset:256
    v_mfma_f32_16x16x32_bf16 v[104:107], v[60:63], v[152:155], v[104:107]
    ds_read_b64_tr_b16 v[220:221], v95 offset:24576
    ds_read_b64_tr_b16 v[222:223], v95 offset:25600
    v_mfma_f32_16x16x32_bf16 v[108:111], v[60:63], v[156:159], v[108:111]
    ds_read_b128 v[60:63], v11 offset:16640
    v_mfma_f32_16x16x32_bf16 v[96:99], v[32:35], v[160:163], v[96:99]
    v_mfma_f32_16x16x32_bf16 v[100:103], v[32:35], v[164:167], v[100:103]
    ds_read_b128 v[32:35], v8 offset:512
    s_waitcnt lgkmcnt(14)
    v_mfma_f32_16x16x32_bf16 v[104:107], v[36:39], v[160:163], v[104:107]
    v_mfma_f32_16x16x32_bf16 v[108:111], v[36:39], v[164:167], v[108:111]
    ds_read_b128 v[36:39], v8 offset:16896
    v_mfma_f32_16x16x32_bf16 v[96:99], v[40:43], v[168:171], v[96:99]
    v_add_u32 v8, 0x8000, v8
    v_mfma_f32_16x16x32_bf16 v[100:103], v[40:43], v[172:175], v[100:103]
    ds_read_b128 v[40:43], v9 offset:512
    s_waitcnt lgkmcnt(12)
    v_mfma_f32_16x16x32_bf16 v[104:107], v[44:47], v[168:171], v[104:107]
    v_mfma_f32_16x16x32_bf16 v[108:111], v[44:47], v[172:175], v[108:111]
    ds_read_b128 v[44:47], v9 offset:16896
    v_mfma_f32_16x16x32_bf16 v[96:99], v[48:51], v[176:179], v[96:99]
    v_add_u32 v9, 0x8000, v9
    v_mfma_f32_16x16x32_bf16 v[100:103], v[48:51], v[180:183], v[100:103]
    ds_read_b128 v[48:51], v10 offset:512
    s_waitcnt lgkmcnt(8)
    v_mfma_f32_16x16x32_bf16 v[104:107], v[52:55], v[176:179], v[104:107]
    v_mfma_f32_16x16x32_bf16 v[108:111], v[52:55], v[180:183], v[108:111]
    ds_read_b128 v[52:55], v10 offset:16896
    v_mfma_f32_16x16x32_bf16 v[96:99], v[56:59], v[184:187], v[96:99]
    v_add_u32 v10, 0x8000, v10
    v_mfma_f32_16x16x32_bf16 v[100:103], v[56:59], v[188:191], v[100:103]
    ds_read_b128 v[56:59], v11 offset:512
    s_waitcnt lgkmcnt(6)
    v_mfma_f32_16x16x32_bf16 v[104:107], v[60:63], v[184:187], v[104:107]
    v_mfma_f32_16x16x32_bf16 v[108:111], v[60:63], v[188:191], v[108:111]
    ds_read_b128 v[60:63], v11 offset:16896
    v_mfma_f32_16x16x32_bf16 v[96:99], v[32:35], v[192:195], v[96:99]
    v_add_u32 v11, 0x8000, v11
    v_mfma_f32_16x16x32_bf16 v[100:103], v[32:35], v[196:199], v[100:103]
    s_waitcnt vmcnt(0)
    s_barrier
    ds_read_b128 v[32:35], v8 offset:0
    s_waitcnt lgkmcnt(6)
    v_mfma_f32_16x16x32_bf16 v[104:107], v[36:39], v[192:195], v[104:107]
    v_mfma_f32_16x16x32_bf16 v[108:111], v[36:39], v[196:199], v[108:111]
    ds_read_b128 v[36:39], v8 offset:16384
    v_mfma_f32_16x16x32_bf16 v[96:99], v[40:43], v[200:203], v[96:99]
    v_mfma_f32_16x16x32_bf16 v[100:103], v[40:43], v[204:207], v[100:103]
    ds_read_b128 v[40:43], v9 offset:0
    s_waitcnt lgkmcnt(6)
    v_mfma_f32_16x16x32_bf16 v[104:107], v[44:47], v[200:203], v[104:107]
    v_mfma_f32_16x16x32_bf16 v[108:111], v[44:47], v[204:207], v[108:111]
    ds_read_b128 v[44:47], v9 offset:16384
    v_mfma_f32_16x16x32_bf16 v[96:99], v[48:51], v[208:211], v[96:99]
    v_mfma_f32_16x16x32_bf16 v[100:103], v[48:51], v[212:215], v[100:103]
    ds_read_b128 v[48:51], v10 offset:0
    s_waitcnt lgkmcnt(6)
    v_mfma_f32_16x16x32_bf16 v[104:107], v[52:55], v[208:211], v[104:107]
    v_mfma_f32_16x16x32_bf16 v[108:111], v[52:55], v[212:215], v[108:111]
    ds_read_b128 v[52:55], v10 offset:16384
    v_mfma_f32_16x16x32_bf16 v[96:99], v[56:59], v[216:219], v[96:99]
    v_mfma_f32_16x16x32_bf16 v[100:103], v[56:59], v[220:223], v[100:103]
    ds_read_b128 v[56:59], v11 offset:0
    s_waitcnt lgkmcnt(6)
    v_mfma_f32_16x16x32_bf16 v[104:107], v[60:63], v[216:219], v[104:107]
    v_mfma_f32_16x16x32_bf16 v[108:111], v[60:63], v[220:223], v[108:111]
    ds_read_b128 v[60:63], v11 offset:16384
    v_mfma_f32_16x16x32_bf16 v[112:115], v[32:35], v[128:131], v[24:27]
    v_mfma_f32_16x16x32_bf16 v[116:119], v[32:35], v[132:135], v[28:31]
    ds_read_b128 v[32:35], v8 offset:256
    s_waitcnt lgkmcnt(6)
    v_mfma_f32_16x16x32_bf16 v[120:123], v[36:39], v[128:131], v[24:27]
    v_mfma_f32_16x16x32_bf16 v[124:127], v[36:39], v[132:135], v[28:31]
    ds_read_b128 v[36:39], v8 offset:16640
    v_mfma_f32_16x16x32_bf16 v[112:115], v[40:43], v[136:139], v[112:115]
    v_mfma_f32_16x16x32_bf16 v[116:119], v[40:43], v[140:143], v[116:119]
    ds_read_b128 v[40:43], v9 offset:256
    s_waitcnt lgkmcnt(6)
    v_mfma_f32_16x16x32_bf16 v[120:123], v[44:47], v[136:139], v[120:123]
    v_mfma_f32_16x16x32_bf16 v[124:127], v[44:47], v[140:143], v[124:127]
    ds_read_b128 v[44:47], v9 offset:16640
    v_mfma_f32_16x16x32_bf16 v[112:115], v[48:51], v[144:147], v[112:115]
    v_mfma_f32_16x16x32_bf16 v[116:119], v[48:51], v[148:151], v[116:119]
    ds_read_b128 v[48:51], v10 offset:256
    s_waitcnt lgkmcnt(6)
    v_mfma_f32_16x16x32_bf16 v[120:123], v[52:55], v[144:147], v[120:123]
    v_mfma_f32_16x16x32_bf16 v[124:127], v[52:55], v[148:151], v[124:127]
    ds_read_b128 v[52:55], v10 offset:16640
    v_mfma_f32_16x16x32_bf16 v[112:115], v[56:59], v[152:155], v[112:115]
    v_mfma_f32_16x16x32_bf16 v[116:119], v[56:59], v[156:159], v[116:119]
    ds_read_b128 v[56:59], v11 offset:256
    s_waitcnt lgkmcnt(6)
    v_mfma_f32_16x16x32_bf16 v[120:123], v[60:63], v[152:155], v[120:123]
    v_mfma_f32_16x16x32_bf16 v[124:127], v[60:63], v[156:159], v[124:127]
    ds_read_b128 v[60:63], v11 offset:16640
    v_mfma_f32_16x16x32_bf16 v[112:115], v[32:35], v[160:163], v[112:115]
    v_mfma_f32_16x16x32_bf16 v[116:119], v[32:35], v[164:167], v[116:119]
    ds_read_b128 v[32:35], v8 offset:512
    s_waitcnt lgkmcnt(6)
    v_mfma_f32_16x16x32_bf16 v[120:123], v[36:39], v[160:163], v[120:123]
    v_mfma_f32_16x16x32_bf16 v[124:127], v[36:39], v[164:167], v[124:127]
    ds_read_b128 v[36:39], v8 offset:16896
    v_mfma_f32_16x16x32_bf16 v[112:115], v[40:43], v[168:171], v[112:115]
    v_subrev_u32 v8, 0x8000, v8
    v_mfma_f32_16x16x32_bf16 v[116:119], v[40:43], v[172:175], v[116:119]
    ds_read_b128 v[40:43], v9 offset:512
    s_waitcnt lgkmcnt(6)
    v_mfma_f32_16x16x32_bf16 v[120:123], v[44:47], v[168:171], v[120:123]
    v_mfma_f32_16x16x32_bf16 v[124:127], v[44:47], v[172:175], v[124:127]
    ds_read_b128 v[44:47], v9 offset:16896
    v_mfma_f32_16x16x32_bf16 v[112:115], v[48:51], v[176:179], v[112:115]
    v_subrev_u32 v9, 0x8000, v9
    v_mfma_f32_16x16x32_bf16 v[116:119], v[48:51], v[180:183], v[116:119]
    s_barrier
    ds_read_b128 v[48:51], v10 offset:512
    s_waitcnt lgkmcnt(6)
    v_mfma_f32_16x16x32_bf16 v[120:123], v[52:55], v[176:179], v[120:123]
    ds_read_b64_tr_b16 v[224:225], v5 offset:32768
    ds_read_b64_tr_b16 v[226:227], v5 offset:33792
    v_mfma_f32_16x16x32_bf16 v[124:127], v[52:55], v[180:183], v[124:127]
    ds_read_b128 v[52:55], v10 offset:16896
    v_mfma_f32_16x16x32_bf16 v[112:115], v[56:59], v[184:187], v[112:115]
    ds_read_b64_tr_b16 v[228:229], v95 offset:32768
    ds_read_b64_tr_b16 v[230:231], v95 offset:33792
    v_subrev_u32 v10, 0x8000, v10
    v_mfma_f32_16x16x32_bf16 v[116:119], v[56:59], v[188:191], v[116:119]
    ds_read_b128 v[56:59], v11 offset:512
    s_waitcnt lgkmcnt(10)
    v_mfma_f32_16x16x32_bf16 v[120:123], v[60:63], v[184:187], v[120:123]
    ds_read_b64_tr_b16 v[232:233], v5 offset:40960
    ds_read_b64_tr_b16 v[234:235], v5 offset:41984
    v_mfma_f32_16x16x32_bf16 v[124:127], v[60:63], v[188:191], v[124:127]
    ds_read_b128 v[60:63], v11 offset:16896
    v_mfma_f32_16x16x32_bf16 v[112:115], v[32:35], v[192:195], v[112:115]
    ds_read_b64_tr_b16 v[236:237], v95 offset:40960
    ds_read_b64_tr_b16 v[238:239], v95 offset:41984
    v_subrev_u32 v11, 0x8000, v11
    v_mfma_f32_16x16x32_bf16 v[116:119], v[32:35], v[196:199], v[116:119]
    ds_read_b128 v[32:35], v8 offset:768
    s_waitcnt lgkmcnt(14)
    v_mfma_f32_16x16x32_bf16 v[120:123], v[36:39], v[192:195], v[120:123]
    ds_read_b64_tr_b16 v[240:241], v5 offset:49152
    ds_read_b64_tr_b16 v[242:243], v5 offset:50176
    v_mfma_f32_16x16x32_bf16 v[124:127], v[36:39], v[196:199], v[124:127]
    ds_read_b128 v[36:39], v9 offset:768
    v_mfma_f32_16x16x32_bf16 v[112:115], v[40:43], v[200:203], v[112:115]
    ds_read_b64_tr_b16 v[244:245], v95 offset:49152
    ds_read_b64_tr_b16 v[246:247], v95 offset:50176
    v_mfma_f32_16x16x32_bf16 v[116:119], v[40:43], v[204:207], v[116:119]
    ds_read_b128 v[40:43], v10 offset:768
    s_waitcnt lgkmcnt(14)
    v_mfma_f32_16x16x32_bf16 v[120:123], v[44:47], v[200:203], v[120:123]
    ds_read_b64_tr_b16 v[248:249], v5 offset:57344
    ds_read_b64_tr_b16 v[250:251], v5 offset:58368
    v_mfma_f32_16x16x32_bf16 v[124:127], v[44:47], v[204:207], v[124:127]
    ds_read_b128 v[44:47], v11 offset:768
    v_mfma_f32_16x16x32_bf16 v[112:115], v[48:51], v[208:211], v[112:115]
    ds_read_b64_tr_b16 v[252:253], v95 offset:57344
    ds_read_b64_tr_b16 v[254:255], v95 offset:58368
    v_mfma_f32_16x16x32_bf16 v[116:119], v[48:51], v[212:215], v[116:119]
    ds_read_b128 v[48:51], v8 offset:17152
    v_mfma_f32_16x16x32_bf16 v[120:123], v[52:55], v[208:211], v[120:123]
    v_add_u32 v8, 0x8000, v8
    v_mfma_f32_16x16x32_bf16 v[124:127], v[52:55], v[212:215], v[124:127]
    ds_read_b128 v[52:55], v9 offset:17152
    s_waitcnt lgkmcnt(14)
    v_mfma_f32_16x16x32_bf16 v[112:115], v[56:59], v[216:219], v[112:115]
    v_add_u32 v9, 0x8000, v9
    v_mfma_f32_16x16x32_bf16 v[116:119], v[56:59], v[220:223], v[116:119]
    ds_read_b128 v[56:59], v10 offset:17152
    v_mfma_f32_16x16x32_bf16 v[120:123], v[60:63], v[216:219], v[120:123]
    v_add_u32 v10, 0x8000, v10
    v_mfma_f32_16x16x32_bf16 v[124:127], v[60:63], v[220:223], v[124:127]
    ds_read_b128 v[60:63], v11 offset:17152
    s_waitcnt lgkmcnt(12)
    v_mfma_f32_16x16x32_bf16 v[96:99], v[32:35], v[224:227], v[96:99]
    v_add_u32 v11, 0x8000, v11
    v_mfma_f32_16x16x32_bf16 v[100:103], v[32:35], v[228:231], v[100:103]
    ds_read_b128 v[32:35], v8 offset:768
    v_mfma_f32_16x16x32_bf16 v[96:99], v[36:39], v[232:235], v[96:99]
    v_mfma_f32_16x16x32_bf16 v[100:103], v[36:39], v[236:239], v[100:103]
    ds_read_b128 v[36:39], v9 offset:768
    s_waitcnt lgkmcnt(8)
    v_mfma_f32_16x16x32_bf16 v[96:99], v[40:43], v[240:243], v[96:99]
    v_mfma_f32_16x16x32_bf16 v[100:103], v[40:43], v[244:247], v[100:103]
    ds_read_b128 v[40:43], v10 offset:768
    s_waitcnt lgkmcnt(6)
    v_mfma_f32_16x16x32_bf16 v[96:99], v[44:47], v[248:251], v[96:99]
    v_mfma_f32_16x16x32_bf16 v[100:103], v[44:47], v[252:255], v[100:103]
    ds_read_b128 v[44:47], v11 offset:768
    v_mfma_f32_16x16x32_bf16 v[104:107], v[48:51], v[224:227], v[104:107]
    v_mfma_f32_16x16x32_bf16 v[108:111], v[48:51], v[228:231], v[108:111]
    ds_read_b128 v[48:51], v8 offset:17152
    s_waitcnt lgkmcnt(6)
    v_mfma_f32_16x16x32_bf16 v[104:107], v[52:55], v[232:235], v[104:107]
    v_add_u32 v8, 0x8000, v8
    v_mfma_f32_16x16x32_bf16 v[108:111], v[52:55], v[236:239], v[108:111]
    ds_read_b128 v[52:55], v9 offset:17152
    v_mfma_f32_16x16x32_bf16 v[104:107], v[56:59], v[240:243], v[104:107]
    v_cvt_pk_bf16_f32 v64, v96, v100
    v_cvt_pk_bf16_f32 v65, v97, v101
    v_add_u32 v9, 0x8000, v9
    v_mfma_f32_16x16x32_bf16 v[108:111], v[56:59], v[244:247], v[108:111]
    ds_read_b128 v[56:59], v10 offset:17152
    s_waitcnt lgkmcnt(6)
    v_mfma_f32_16x16x32_bf16 v[104:107], v[60:63], v[248:251], v[104:107]
    v_cvt_pk_bf16_f32 v66, v98, v102
    v_cvt_pk_bf16_f32 v67, v99, v103
    v_add_u32 v10, 0x8000, v10
    v_mfma_f32_16x16x32_bf16 v[108:111], v[60:63], v[252:255], v[108:111]
    ds_read_b128 v[60:63], v11 offset:17152
    v_mfma_f32_16x16x32_bf16 v[112:115], v[32:35], v[224:227], v[112:115]
    v_mov_b32_dpp v16, v64 quad_perm:[1,0,3,2] row_mask:0xf bank_mask:0xf
    v_mov_b32_dpp v17, v65 quad_perm:[1,0,3,2] row_mask:0xf bank_mask:0xf
    v_add_u32 v11, 0x8000, v11
    v_mfma_f32_16x16x32_bf16 v[116:119], v[32:35], v[228:231], v[116:119]
    s_barrier
    ds_read_b128 v[32:35], v8 offset:0
    s_waitcnt lgkmcnt(6)
    v_mfma_f32_16x16x32_bf16 v[112:115], v[36:39], v[232:235], v[112:115]
    v_mov_b32_dpp v18, v66 quad_perm:[1,0,3,2] row_mask:0xf bank_mask:0xf
    v_mov_b32_dpp v19, v67 quad_perm:[1,0,3,2] row_mask:0xf bank_mask:0xf
    v_mfma_f32_16x16x32_bf16 v[116:119], v[36:39], v[236:239], v[116:119]
    ds_read_b128 v[36:39], v9 offset:0
    v_mfma_f32_16x16x32_bf16 v[112:115], v[40:43], v[240:243], v[112:115]
    v_perm_b32 v64, v16, v64, v6
    v_perm_b32 v65, v17, v65, v6
    v_mfma_f32_16x16x32_bf16 v[116:119], v[40:43], v[244:247], v[116:119]
    ds_read_b128 v[40:43], v10 offset:0
    s_waitcnt lgkmcnt(6)
    v_mfma_f32_16x16x32_bf16 v[112:115], v[44:47], v[248:251], v[112:115]
    v_perm_b32 v66, v18, v66, v6
    v_perm_b32 v67, v19, v67, v6
    v_mfma_f32_16x16x32_bf16 v[116:119], v[44:47], v[252:255], v[116:119]
    ds_read_b128 v[44:47], v11 offset:0
    v_mfma_f32_16x16x32_bf16 v[120:123], v[48:51], v[224:227], v[120:123]
    v_cvt_pk_bf16_f32 v68, v104, v108
    v_cvt_pk_bf16_f32 v69, v105, v109
    v_mfma_f32_16x16x32_bf16 v[124:127], v[48:51], v[228:231], v[124:127]
    ds_read_b128 v[48:51], v8 offset:256
    s_waitcnt lgkmcnt(6)
    v_mfma_f32_16x16x32_bf16 v[120:123], v[52:55], v[232:235], v[120:123]
    v_cvt_pk_bf16_f32 v70, v106, v110
    v_cvt_pk_bf16_f32 v71, v107, v111
    v_mfma_f32_16x16x32_bf16 v[124:127], v[52:55], v[236:239], v[124:127]
    ds_read_b128 v[52:55], v9 offset:256
    v_mfma_f32_16x16x32_bf16 v[120:123], v[56:59], v[240:243], v[120:123]
    v_mov_b32_dpp v16, v68 quad_perm:[1,0,3,2] row_mask:0xf bank_mask:0xf
    v_mov_b32_dpp v17, v69 quad_perm:[1,0,3,2] row_mask:0xf bank_mask:0xf
    v_mfma_f32_16x16x32_bf16 v[124:127], v[56:59], v[244:247], v[124:127]
    ds_read_b128 v[56:59], v10 offset:256
    s_waitcnt lgkmcnt(6)
    v_mfma_f32_16x16x32_bf16 v[120:123], v[60:63], v[248:251], v[120:123]
    v_mov_b32_dpp v18, v70 quad_perm:[1,0,3,2] row_mask:0xf bank_mask:0xf
    v_mov_b32_dpp v19, v71 quad_perm:[1,0,3,2] row_mask:0xf bank_mask:0xf
    v_mfma_f32_16x16x32_bf16 v[124:127], v[60:63], v[252:255], v[124:127]
    ds_read_b128 v[60:63], v11 offset:256
    v_mfma_f32_16x16x32_bf16 v[96:99], v[32:35], v[128:131], v[24:27]
    v_perm_b32 v68, v16, v68, v6
    v_perm_b32 v69, v17, v69, v6
    v_mfma_f32_16x16x32_bf16 v[100:103], v[32:35], v[132:135], v[28:31]
    s_barrier
    ds_read_b128 v[32:35], v8 offset:512
    s_waitcnt lgkmcnt(6)
    v_mfma_f32_16x16x32_bf16 v[96:99], v[36:39], v[136:139], v[96:99]
    v_perm_b32 v70, v18, v70, v6
    v_perm_b32 v71, v19, v71, v6
    v_mfma_f32_16x16x32_bf16 v[100:103], v[36:39], v[140:143], v[100:103]
    ds_read_b128 v[36:39], v9 offset:512
    v_mfma_f32_16x16x32_bf16 v[96:99], v[40:43], v[144:147], v[96:99]
    v_cvt_pk_bf16_f32 v72, v112, v116
    v_cvt_pk_bf16_f32 v73, v113, v117
    v_mfma_f32_16x16x32_bf16 v[100:103], v[40:43], v[148:151], v[100:103]
    ds_read_b128 v[40:43], v10 offset:512
    s_waitcnt lgkmcnt(6)
    v_mfma_f32_16x16x32_bf16 v[96:99], v[44:47], v[152:155], v[96:99]
    v_cvt_pk_bf16_f32 v74, v114, v118
    v_cvt_pk_bf16_f32 v75, v115, v119
    v_mfma_f32_16x16x32_bf16 v[100:103], v[44:47], v[156:159], v[100:103]
    ds_read_b128 v[44:47], v11 offset:512
    v_mfma_f32_16x16x32_bf16 v[96:99], v[48:51], v[160:163], v[96:99]
    v_mov_b32_dpp v16, v72 quad_perm:[1,0,3,2] row_mask:0xf bank_mask:0xf
    v_mov_b32_dpp v17, v73 quad_perm:[1,0,3,2] row_mask:0xf bank_mask:0xf
    v_mfma_f32_16x16x32_bf16 v[100:103], v[48:51], v[164:167], v[100:103]
    ds_read_b128 v[48:51], v8 offset:768
    s_waitcnt lgkmcnt(6)
    v_mfma_f32_16x16x32_bf16 v[96:99], v[52:55], v[168:171], v[96:99]
    v_mov_b32_dpp v18, v74 quad_perm:[1,0,3,2] row_mask:0xf bank_mask:0xf
    v_mov_b32_dpp v19, v75 quad_perm:[1,0,3,2] row_mask:0xf bank_mask:0xf
    v_mfma_f32_16x16x32_bf16 v[100:103], v[52:55], v[172:175], v[100:103]
    ds_read_b128 v[52:55], v9 offset:768
    v_mfma_f32_16x16x32_bf16 v[96:99], v[56:59], v[176:179], v[96:99]
    v_perm_b32 v72, v16, v72, v6
    v_perm_b32 v73, v17, v73, v6
    v_mfma_f32_16x16x32_bf16 v[100:103], v[56:59], v[180:183], v[100:103]
    ds_read_b128 v[56:59], v10 offset:768
    s_waitcnt lgkmcnt(6)
    v_mfma_f32_16x16x32_bf16 v[96:99], v[60:63], v[184:187], v[96:99]
    v_perm_b32 v74, v18, v74, v6
    v_perm_b32 v75, v19, v75, v6
    v_mfma_f32_16x16x32_bf16 v[100:103], v[60:63], v[188:191], v[100:103]
    ds_read_b128 v[60:63], v11 offset:768
    v_mfma_f32_16x16x32_bf16 v[96:99], v[32:35], v[192:195], v[96:99]
    v_cvt_pk_bf16_f32 v76, v120, v124
    v_cvt_pk_bf16_f32 v77, v121, v125
    v_mfma_f32_16x16x32_bf16 v[100:103], v[32:35], v[196:199], v[100:103]
    ds_read_b128 v[32:35], v8 offset:16384
    s_waitcnt lgkmcnt(6)
    v_mfma_f32_16x16x32_bf16 v[96:99], v[36:39], v[200:203], v[96:99]
    v_cvt_pk_bf16_f32 v78, v122, v126
    v_cvt_pk_bf16_f32 v79, v123, v127
    v_mfma_f32_16x16x32_bf16 v[100:103], v[36:39], v[204:207], v[100:103]
    ds_read_b128 v[36:39], v9 offset:16384
    v_mfma_f32_16x16x32_bf16 v[96:99], v[40:43], v[208:211], v[96:99]
    v_mov_b32_dpp v16, v76 quad_perm:[1,0,3,2] row_mask:0xf bank_mask:0xf
    v_mov_b32_dpp v17, v77 quad_perm:[1,0,3,2] row_mask:0xf bank_mask:0xf
    v_mfma_f32_16x16x32_bf16 v[100:103], v[40:43], v[212:215], v[100:103]
    ds_read_b128 v[40:43], v10 offset:16384
    s_waitcnt lgkmcnt(6)
    v_mfma_f32_16x16x32_bf16 v[96:99], v[44:47], v[216:219], v[96:99]
    v_mov_b32_dpp v18, v78 quad_perm:[1,0,3,2] row_mask:0xf bank_mask:0xf
    v_mov_b32_dpp v19, v79 quad_perm:[1,0,3,2] row_mask:0xf bank_mask:0xf
    v_mfma_f32_16x16x32_bf16 v[100:103], v[44:47], v[220:223], v[100:103]
    ds_read_b128 v[44:47], v11 offset:16384
    v_mfma_f32_16x16x32_bf16 v[96:99], v[48:51], v[224:227], v[96:99]
    v_perm_b32 v76, v16, v76, v6
    v_perm_b32 v77, v17, v77, v6
    v_mfma_f32_16x16x32_bf16 v[100:103], v[48:51], v[228:231], v[100:103]
    ds_read_b128 v[48:51], v8 offset:16640
    s_waitcnt lgkmcnt(6)
    v_mfma_f32_16x16x32_bf16 v[96:99], v[52:55], v[232:235], v[96:99]
    v_perm_b32 v78, v18, v78, v6
    v_perm_b32 v79, v19, v79, v6
    v_mfma_f32_16x16x32_bf16 v[100:103], v[52:55], v[236:239], v[100:103]
    ds_read_b128 v[52:55], v9 offset:16640
    v_mfma_f32_16x16x32_bf16 v[96:99], v[56:59], v[240:243], v[96:99]
    v_mfma_f32_16x16x32_bf16 v[100:103], v[56:59], v[244:247], v[100:103]
    ds_read_b128 v[56:59], v10 offset:16640
    s_waitcnt lgkmcnt(6)
    v_mfma_f32_16x16x32_bf16 v[96:99], v[60:63], v[248:251], v[96:99]
    v_mfma_f32_16x16x32_bf16 v[100:103], v[60:63], v[252:255], v[100:103]
    ds_read_b128 v[60:63], v11 offset:16640
    v_mfma_f32_16x16x32_bf16 v[104:107], v[32:35], v[128:131], v[24:27]
    v_mfma_f32_16x16x32_bf16 v[108:111], v[32:35], v[132:135], v[28:31]
    ds_read_b128 v[32:35], v8 offset:16896
    s_waitcnt lgkmcnt(6)
    v_mfma_f32_16x16x32_bf16 v[104:107], v[36:39], v[136:139], v[104:107]
    v_mfma_f32_16x16x32_bf16 v[108:111], v[36:39], v[140:143], v[108:111]
    ds_read_b128 v[36:39], v9 offset:16896
    v_mfma_f32_16x16x32_bf16 v[104:107], v[40:43], v[144:147], v[104:107]
    v_cvt_pk_bf16_f32 v80, v96, v100
    v_cvt_pk_bf16_f32 v81, v97, v101
    v_mfma_f32_16x16x32_bf16 v[108:111], v[40:43], v[148:151], v[108:111]
    ds_read_b128 v[40:43], v10 offset:16896
    s_waitcnt lgkmcnt(6)
    v_mfma_f32_16x16x32_bf16 v[104:107], v[44:47], v[152:155], v[104:107]
    v_cvt_pk_bf16_f32 v82, v98, v102
    v_cvt_pk_bf16_f32 v83, v99, v103
    v_mfma_f32_16x16x32_bf16 v[108:111], v[44:47], v[156:159], v[108:111]
    ds_read_b128 v[44:47], v11 offset:16896
    v_mfma_f32_16x16x32_bf16 v[104:107], v[48:51], v[160:163], v[104:107]
    v_mov_b32_dpp v16, v80 quad_perm:[1,0,3,2] row_mask:0xf bank_mask:0xf
    v_mov_b32_dpp v17, v81 quad_perm:[1,0,3,2] row_mask:0xf bank_mask:0xf
    v_mfma_f32_16x16x32_bf16 v[108:111], v[48:51], v[164:167], v[108:111]
    ds_read_b128 v[48:51], v8 offset:17152
    s_waitcnt lgkmcnt(6)
    v_mfma_f32_16x16x32_bf16 v[104:107], v[52:55], v[168:171], v[104:107]
    v_mov_b32_dpp v18, v82 quad_perm:[1,0,3,2] row_mask:0xf bank_mask:0xf
    v_mov_b32_dpp v19, v83 quad_perm:[1,0,3,2] row_mask:0xf bank_mask:0xf
    v_add_u32 v8, 0x8000, v8
    v_mfma_f32_16x16x32_bf16 v[108:111], v[52:55], v[172:175], v[108:111]
    ds_read_b128 v[52:55], v9 offset:17152
    v_mfma_f32_16x16x32_bf16 v[104:107], v[56:59], v[176:179], v[104:107]
    v_perm_b32 v80, v16, v80, v6
    v_perm_b32 v81, v17, v81, v6
    v_add_u32 v9, 0x8000, v9
    v_mfma_f32_16x16x32_bf16 v[108:111], v[56:59], v[180:183], v[108:111]
    ds_read_b128 v[56:59], v10 offset:17152
    s_waitcnt lgkmcnt(6)
    v_mfma_f32_16x16x32_bf16 v[104:107], v[60:63], v[184:187], v[104:107]
    v_perm_b32 v82, v18, v82, v6
    v_perm_b32 v83, v19, v83, v6
    v_add_u32 v10, 0x8000, v10
    v_mfma_f32_16x16x32_bf16 v[108:111], v[60:63], v[188:191], v[108:111]
    ds_read_b128 v[60:63], v11 offset:17152
    v_mfma_f32_16x16x32_bf16 v[104:107], v[32:35], v[192:195], v[104:107]
    v_add_u32 v11, 0x8000, v11
    v_mfma_f32_16x16x32_bf16 v[108:111], v[32:35], v[196:199], v[108:111]
    s_barrier
    ds_read_b128 v[32:35], v8 offset:0
    s_waitcnt lgkmcnt(6)
    v_mfma_f32_16x16x32_bf16 v[104:107], v[36:39], v[200:203], v[104:107]
    v_mfma_f32_16x16x32_bf16 v[108:111], v[36:39], v[204:207], v[108:111]
    ds_read_b128 v[36:39], v9 offset:0
    v_mfma_f32_16x16x32_bf16 v[104:107], v[40:43], v[208:211], v[104:107]
    v_mfma_f32_16x16x32_bf16 v[108:111], v[40:43], v[212:215], v[108:111]
    ds_read_b128 v[40:43], v10 offset:0
    s_waitcnt lgkmcnt(6)
    v_mfma_f32_16x16x32_bf16 v[104:107], v[44:47], v[216:219], v[104:107]
    v_mfma_f32_16x16x32_bf16 v[108:111], v[44:47], v[220:223], v[108:111]
    ds_read_b128 v[44:47], v11 offset:0
    v_mfma_f32_16x16x32_bf16 v[104:107], v[48:51], v[224:227], v[104:107]
    buffer_store_dword v64, v7, s[20:23], s32 offen offset:0 nt
    v_mfma_f32_16x16x32_bf16 v[108:111], v[48:51], v[228:231], v[108:111]
    ds_read_b128 v[48:51], v8 offset:256
    s_waitcnt lgkmcnt(6)
    v_mfma_f32_16x16x32_bf16 v[104:107], v[52:55], v[232:235], v[104:107]
    buffer_store_dword v65, v7, s[20:23], s32 offen offset:1024 nt
    v_mfma_f32_16x16x32_bf16 v[108:111], v[52:55], v[236:239], v[108:111]
    ds_read_b128 v[52:55], v9 offset:256
    v_mfma_f32_16x16x32_bf16 v[104:107], v[56:59], v[240:243], v[104:107]
    buffer_store_dword v66, v7, s[20:23], s32 offen offset:2048 nt
    v_mfma_f32_16x16x32_bf16 v[108:111], v[56:59], v[244:247], v[108:111]
    ds_read_b128 v[56:59], v10 offset:256
    s_waitcnt lgkmcnt(6)
    v_mfma_f32_16x16x32_bf16 v[104:107], v[60:63], v[248:251], v[104:107]
    buffer_store_dword v67, v7, s[20:23], s32 offen offset:3072 nt
    v_mfma_f32_16x16x32_bf16 v[108:111], v[60:63], v[252:255], v[108:111]
    ds_read_b128 v[60:63], v11 offset:256
    v_mfma_f32_16x16x32_bf16 v[112:115], v[32:35], v[128:131], v[24:27]
    s_add_u32 s5, s32, 0x4000
    buffer_store_dword v68, v7, s[20:23], s5 offen offset:0 nt
    v_mfma_f32_16x16x32_bf16 v[116:119], v[32:35], v[132:135], v[28:31]
    ds_read_b128 v[32:35], v8 offset:512
    s_waitcnt lgkmcnt(6)
    v_mfma_f32_16x16x32_bf16 v[112:115], v[36:39], v[136:139], v[112:115]
    buffer_store_dword v69, v7, s[20:23], s5 offen offset:1024 nt
    v_mfma_f32_16x16x32_bf16 v[116:119], v[36:39], v[140:143], v[116:119]
    ds_read_b128 v[36:39], v9 offset:512
    v_mfma_f32_16x16x32_bf16 v[112:115], v[40:43], v[144:147], v[112:115]
    v_cvt_pk_bf16_f32 v84, v104, v108
    v_cvt_pk_bf16_f32 v85, v105, v109
    v_mfma_f32_16x16x32_bf16 v[116:119], v[40:43], v[148:151], v[116:119]
    ds_read_b128 v[40:43], v10 offset:512
    s_waitcnt lgkmcnt(6)
    v_mfma_f32_16x16x32_bf16 v[112:115], v[44:47], v[152:155], v[112:115]
    v_cvt_pk_bf16_f32 v86, v106, v110
    v_cvt_pk_bf16_f32 v87, v107, v111
    v_mfma_f32_16x16x32_bf16 v[116:119], v[44:47], v[156:159], v[116:119]
    ds_read_b128 v[44:47], v11 offset:512
    v_mfma_f32_16x16x32_bf16 v[112:115], v[48:51], v[160:163], v[112:115]
    v_mov_b32_dpp v16, v84 quad_perm:[1,0,3,2] row_mask:0xf bank_mask:0xf
    v_mov_b32_dpp v17, v85 quad_perm:[1,0,3,2] row_mask:0xf bank_mask:0xf
    v_mfma_f32_16x16x32_bf16 v[116:119], v[48:51], v[164:167], v[116:119]
    ds_read_b128 v[48:51], v8 offset:768
    s_waitcnt lgkmcnt(6)
    v_mfma_f32_16x16x32_bf16 v[112:115], v[52:55], v[168:171], v[112:115]
    v_mov_b32_dpp v18, v86 quad_perm:[1,0,3,2] row_mask:0xf bank_mask:0xf
    v_mov_b32_dpp v19, v87 quad_perm:[1,0,3,2] row_mask:0xf bank_mask:0xf
    v_mfma_f32_16x16x32_bf16 v[116:119], v[52:55], v[172:175], v[116:119]
    ds_read_b128 v[52:55], v9 offset:768
    v_mfma_f32_16x16x32_bf16 v[112:115], v[56:59], v[176:179], v[112:115]
    v_perm_b32 v84, v16, v84, v6
    v_perm_b32 v85, v17, v85, v6
    v_mfma_f32_16x16x32_bf16 v[116:119], v[56:59], v[180:183], v[116:119]
    ds_read_b128 v[56:59], v10 offset:768
    s_waitcnt lgkmcnt(6)
    v_mfma_f32_16x16x32_bf16 v[112:115], v[60:63], v[184:187], v[112:115]
    v_perm_b32 v86, v18, v86, v6
    v_perm_b32 v87, v19, v87, v6
    v_mfma_f32_16x16x32_bf16 v[116:119], v[60:63], v[188:191], v[116:119]
    ds_read_b128 v[60:63], v11 offset:768
    v_mfma_f32_16x16x32_bf16 v[112:115], v[32:35], v[192:195], v[112:115]
    buffer_store_dword v70, v7, s[20:23], s5 offen offset:2048 nt
    v_mfma_f32_16x16x32_bf16 v[116:119], v[32:35], v[196:199], v[116:119]
    ds_read_b128 v[32:35], v8 offset:16384
    s_waitcnt lgkmcnt(6)
    v_mfma_f32_16x16x32_bf16 v[112:115], v[36:39], v[200:203], v[112:115]
    buffer_store_dword v71, v7, s[20:23], s5 offen offset:3072 nt
    v_mfma_f32_16x16x32_bf16 v[116:119], v[36:39], v[204:207], v[116:119]
    ds_read_b128 v[36:39], v9 offset:16384
    v_mfma_f32_16x16x32_bf16 v[112:115], v[40:43], v[208:211], v[112:115]
    buffer_store_dword v72, v7, s[20:23], s33 offen offset:0 nt
    v_mfma_f32_16x16x32_bf16 v[116:119], v[40:43], v[212:215], v[116:119]
    ds_read_b128 v[40:43], v10 offset:16384
    s_waitcnt lgkmcnt(6)
    v_mfma_f32_16x16x32_bf16 v[112:115], v[44:47], v[216:219], v[112:115]
    buffer_store_dword v73, v7, s[20:23], s33 offen offset:1024 nt
    v_mfma_f32_16x16x32_bf16 v[116:119], v[44:47], v[220:223], v[116:119]
    ds_read_b128 v[44:47], v11 offset:16384
    v_mfma_f32_16x16x32_bf16 v[112:115], v[48:51], v[224:227], v[112:115]
    buffer_store_dword v74, v7, s[20:23], s33 offen offset:2048 nt
    v_mfma_f32_16x16x32_bf16 v[116:119], v[48:51], v[228:231], v[116:119]
    ds_read_b128 v[48:51], v8 offset:16640
    s_waitcnt lgkmcnt(6)
    v_mfma_f32_16x16x32_bf16 v[112:115], v[52:55], v[232:235], v[112:115]
    buffer_store_dword v75, v7, s[20:23], s33 offen offset:3072 nt
    v_mfma_f32_16x16x32_bf16 v[116:119], v[52:55], v[236:239], v[116:119]
    ds_read_b128 v[52:55], v9 offset:16640
    v_mfma_f32_16x16x32_bf16 v[112:115], v[56:59], v[240:243], v[112:115]
    s_add_u32 s5, s33, 0x4000
    buffer_store_dword v76, v7, s[20:23], s5 offen offset:0 nt
    v_mfma_f32_16x16x32_bf16 v[116:119], v[56:59], v[244:247], v[116:119]
    ds_read_b128 v[56:59], v10 offset:16640
    s_waitcnt lgkmcnt(6)
    v_mfma_f32_16x16x32_bf16 v[112:115], v[60:63], v[248:251], v[112:115]
    buffer_store_dword v77, v7, s[20:23], s5 offen offset:1024 nt
    v_mfma_f32_16x16x32_bf16 v[116:119], v[60:63], v[252:255], v[116:119]
    ds_read_b128 v[60:63], v11 offset:16640
    v_mfma_f32_16x16x32_bf16 v[120:123], v[32:35], v[128:131], v[24:27]
    buffer_store_dword v78, v7, s[20:23], s5 offen offset:2048 nt
    v_mfma_f32_16x16x32_bf16 v[124:127], v[32:35], v[132:135], v[28:31]
    ds_read_b128 v[32:35], v8 offset:16896
    s_waitcnt lgkmcnt(6)
    v_mfma_f32_16x16x32_bf16 v[120:123], v[36:39], v[136:139], v[120:123]
    buffer_store_dword v79, v7, s[20:23], s5 offen offset:3072 nt
    v_mfma_f32_16x16x32_bf16 v[124:127], v[36:39], v[140:143], v[124:127]
    ds_read_b128 v[36:39], v9 offset:16896
    v_mfma_f32_16x16x32_bf16 v[120:123], v[40:43], v[144:147], v[120:123]
    v_cvt_pk_bf16_f32 v88, v112, v116
    v_cvt_pk_bf16_f32 v89, v113, v117
    v_mfma_f32_16x16x32_bf16 v[124:127], v[40:43], v[148:151], v[124:127]
    ds_read_b128 v[40:43], v10 offset:16896
    s_waitcnt lgkmcnt(6)
    v_mfma_f32_16x16x32_bf16 v[120:123], v[44:47], v[152:155], v[120:123]
    v_cvt_pk_bf16_f32 v90, v114, v118
    v_cvt_pk_bf16_f32 v91, v115, v119
    v_mfma_f32_16x16x32_bf16 v[124:127], v[44:47], v[156:159], v[124:127]
    ds_read_b128 v[44:47], v11 offset:16896
    v_mfma_f32_16x16x32_bf16 v[120:123], v[48:51], v[160:163], v[120:123]
    v_mov_b32_dpp v16, v88 quad_perm:[1,0,3,2] row_mask:0xf bank_mask:0xf
    v_mov_b32_dpp v17, v89 quad_perm:[1,0,3,2] row_mask:0xf bank_mask:0xf
    v_mfma_f32_16x16x32_bf16 v[124:127], v[48:51], v[164:167], v[124:127]
    ds_read_b128 v[48:51], v8 offset:17152
    s_waitcnt lgkmcnt(6)
    v_mfma_f32_16x16x32_bf16 v[120:123], v[52:55], v[168:171], v[120:123]
    v_mov_b32_dpp v18, v90 quad_perm:[1,0,3,2] row_mask:0xf bank_mask:0xf
    v_mov_b32_dpp v19, v91 quad_perm:[1,0,3,2] row_mask:0xf bank_mask:0xf
    v_add_u32 v8, 0x8000, v8
    v_mfma_f32_16x16x32_bf16 v[124:127], v[52:55], v[172:175], v[124:127]
    ds_read_b128 v[52:55], v9 offset:17152
    v_mfma_f32_16x16x32_bf16 v[120:123], v[56:59], v[176:179], v[120:123]
    v_perm_b32 v88, v16, v88, v6
    v_perm_b32 v89, v17, v89, v6
    v_add_u32 v9, 0x8000, v9
    v_mfma_f32_16x16x32_bf16 v[124:127], v[56:59], v[180:183], v[124:127]
    ds_read_b128 v[56:59], v10 offset:17152
    s_waitcnt lgkmcnt(6)
    v_mfma_f32_16x16x32_bf16 v[120:123], v[60:63], v[184:187], v[120:123]
    v_perm_b32 v90, v18, v90, v6
    v_perm_b32 v91, v19, v91, v6
    v_add_u32 v10, 0x8000, v10
    v_mfma_f32_16x16x32_bf16 v[124:127], v[60:63], v[188:191], v[124:127]
    ds_read_b128 v[60:63], v11 offset:17152
    v_mfma_f32_16x16x32_bf16 v[120:123], v[32:35], v[192:195], v[120:123]
    buffer_store_dword v80, v7, s[20:23], s34 offen offset:0 nt
    v_add_u32 v11, 0x8000, v11
    v_mfma_f32_16x16x32_bf16 v[124:127], v[32:35], v[196:199], v[124:127]
    s_barrier
    ds_read_b128 v[32:35], v8 offset:0
    s_waitcnt lgkmcnt(6)
    v_mfma_f32_16x16x32_bf16 v[120:123], v[36:39], v[200:203], v[120:123]
    buffer_store_dword v81, v7, s[20:23], s34 offen offset:1024 nt
    v_mfma_f32_16x16x32_bf16 v[124:127], v[36:39], v[204:207], v[124:127]
    ds_read_b128 v[36:39], v9 offset:0
    v_mfma_f32_16x16x32_bf16 v[120:123], v[40:43], v[208:211], v[120:123]
    buffer_store_dword v82, v7, s[20:23], s34 offen offset:2048 nt
    v_mfma_f32_16x16x32_bf16 v[124:127], v[40:43], v[212:215], v[124:127]
    ds_read_b128 v[40:43], v10 offset:0
    s_waitcnt lgkmcnt(6)
    v_mfma_f32_16x16x32_bf16 v[120:123], v[44:47], v[216:219], v[120:123]
    buffer_store_dword v83, v7, s[20:23], s34 offen offset:3072 nt
    v_mfma_f32_16x16x32_bf16 v[124:127], v[44:47], v[220:223], v[124:127]
    ds_read_b128 v[44:47], v11 offset:0
    v_mfma_f32_16x16x32_bf16 v[120:123], v[48:51], v[224:227], v[120:123]
    s_add_u32 s5, s34, 0x4000
    buffer_store_dword v84, v7, s[20:23], s5 offen offset:0 nt
    v_mfma_f32_16x16x32_bf16 v[124:127], v[48:51], v[228:231], v[124:127]
    ds_read_b128 v[48:51], v8 offset:256
    s_waitcnt lgkmcnt(6)
    v_mfma_f32_16x16x32_bf16 v[120:123], v[52:55], v[232:235], v[120:123]
    buffer_store_dword v85, v7, s[20:23], s5 offen offset:1024 nt
    v_mfma_f32_16x16x32_bf16 v[124:127], v[52:55], v[236:239], v[124:127]
    ds_read_b128 v[52:55], v9 offset:256
    v_mfma_f32_16x16x32_bf16 v[120:123], v[56:59], v[240:243], v[120:123]
    buffer_store_dword v86, v7, s[20:23], s5 offen offset:2048 nt
    v_mfma_f32_16x16x32_bf16 v[124:127], v[56:59], v[244:247], v[124:127]
    ds_read_b128 v[56:59], v10 offset:256
    s_waitcnt lgkmcnt(6)
    v_mfma_f32_16x16x32_bf16 v[120:123], v[60:63], v[248:251], v[120:123]
    buffer_store_dword v87, v7, s[20:23], s5 offen offset:3072 nt
    v_mfma_f32_16x16x32_bf16 v[124:127], v[60:63], v[252:255], v[124:127]
    ds_read_b128 v[60:63], v11 offset:256
    v_mfma_f32_16x16x32_bf16 v[96:99], v[32:35], v[128:131], v[24:27]
    buffer_store_dword v88, v7, s[20:23], s35 offen offset:0 nt
    v_mfma_f32_16x16x32_bf16 v[100:103], v[32:35], v[132:135], v[28:31]
    ds_read_b128 v[32:35], v8 offset:512
    s_waitcnt lgkmcnt(6)
    v_mfma_f32_16x16x32_bf16 v[96:99], v[36:39], v[136:139], v[96:99]
    buffer_store_dword v89, v7, s[20:23], s35 offen offset:1024 nt
    v_mfma_f32_16x16x32_bf16 v[100:103], v[36:39], v[140:143], v[100:103]
    ds_read_b128 v[36:39], v9 offset:512
    v_mfma_f32_16x16x32_bf16 v[96:99], v[40:43], v[144:147], v[96:99]
    v_cvt_pk_bf16_f32 v92, v120, v124
    v_cvt_pk_bf16_f32 v93, v121, v125
    v_mfma_f32_16x16x32_bf16 v[100:103], v[40:43], v[148:151], v[100:103]
    ds_read_b128 v[40:43], v10 offset:512
    s_waitcnt lgkmcnt(6)
    v_mfma_f32_16x16x32_bf16 v[96:99], v[44:47], v[152:155], v[96:99]
    v_cvt_pk_bf16_f32 v94, v122, v126
    v_cvt_pk_bf16_f32 v95, v123, v127
    v_mfma_f32_16x16x32_bf16 v[100:103], v[44:47], v[156:159], v[100:103]
    ds_read_b128 v[44:47], v11 offset:512
    v_mfma_f32_16x16x32_bf16 v[96:99], v[48:51], v[160:163], v[96:99]
    v_mov_b32_dpp v16, v92 quad_perm:[1,0,3,2] row_mask:0xf bank_mask:0xf
    v_mov_b32_dpp v17, v93 quad_perm:[1,0,3,2] row_mask:0xf bank_mask:0xf
    v_mfma_f32_16x16x32_bf16 v[100:103], v[48:51], v[164:167], v[100:103]
    ds_read_b128 v[48:51], v8 offset:768
    s_waitcnt lgkmcnt(6)
    v_mfma_f32_16x16x32_bf16 v[96:99], v[52:55], v[168:171], v[96:99]
    v_mov_b32_dpp v18, v94 quad_perm:[1,0,3,2] row_mask:0xf bank_mask:0xf
    v_mov_b32_dpp v19, v95 quad_perm:[1,0,3,2] row_mask:0xf bank_mask:0xf
    v_mfma_f32_16x16x32_bf16 v[100:103], v[52:55], v[172:175], v[100:103]
    ds_read_b128 v[52:55], v9 offset:768
    v_mfma_f32_16x16x32_bf16 v[96:99], v[56:59], v[176:179], v[96:99]
    v_perm_b32 v92, v16, v92, v6
    v_perm_b32 v93, v17, v93, v6
    v_mfma_f32_16x16x32_bf16 v[100:103], v[56:59], v[180:183], v[100:103]
    ds_read_b128 v[56:59], v10 offset:768
    s_waitcnt lgkmcnt(6)
    v_mfma_f32_16x16x32_bf16 v[96:99], v[60:63], v[184:187], v[96:99]
    v_perm_b32 v94, v18, v94, v6
    v_perm_b32 v95, v19, v95, v6
    v_mfma_f32_16x16x32_bf16 v[100:103], v[60:63], v[188:191], v[100:103]
    ds_read_b128 v[60:63], v11 offset:768
    v_mfma_f32_16x16x32_bf16 v[96:99], v[32:35], v[192:195], v[96:99]
    buffer_store_dword v90, v7, s[20:23], s35 offen offset:2048 nt
    v_mfma_f32_16x16x32_bf16 v[100:103], v[32:35], v[196:199], v[100:103]
    ds_read_b128 v[32:35], v8 offset:16384
    s_waitcnt lgkmcnt(6)
    v_mfma_f32_16x16x32_bf16 v[96:99], v[36:39], v[200:203], v[96:99]
    buffer_store_dword v91, v7, s[20:23], s35 offen offset:3072 nt
    v_mfma_f32_16x16x32_bf16 v[100:103], v[36:39], v[204:207], v[100:103]
    ds_read_b128 v[36:39], v9 offset:16384
    v_mfma_f32_16x16x32_bf16 v[96:99], v[40:43], v[208:211], v[96:99]
    s_add_u32 s5, s35, 0x4000
    buffer_store_dword v92, v7, s[20:23], s5 offen offset:0 nt
    v_mfma_f32_16x16x32_bf16 v[100:103], v[40:43], v[212:215], v[100:103]
    ds_read_b128 v[40:43], v10 offset:16384
    s_waitcnt lgkmcnt(6)
    v_mfma_f32_16x16x32_bf16 v[96:99], v[44:47], v[216:219], v[96:99]
    buffer_store_dword v93, v7, s[20:23], s5 offen offset:1024 nt
    v_mfma_f32_16x16x32_bf16 v[100:103], v[44:47], v[220:223], v[100:103]
    ds_read_b128 v[44:47], v11 offset:16384
    v_mfma_f32_16x16x32_bf16 v[96:99], v[48:51], v[224:227], v[96:99]
    buffer_store_dword v94, v7, s[20:23], s5 offen offset:2048 nt
    v_mfma_f32_16x16x32_bf16 v[100:103], v[48:51], v[228:231], v[100:103]
    ds_read_b128 v[48:51], v8 offset:16640
    s_waitcnt lgkmcnt(6)
    v_mfma_f32_16x16x32_bf16 v[96:99], v[52:55], v[232:235], v[96:99]
    buffer_store_dword v95, v7, s[20:23], s5 offen offset:3072 nt
    v_mfma_f32_16x16x32_bf16 v[100:103], v[52:55], v[236:239], v[100:103]
    ds_read_b128 v[52:55], v9 offset:16640
    v_mfma_f32_16x16x32_bf16 v[96:99], v[56:59], v[240:243], v[96:99]
    v_mfma_f32_16x16x32_bf16 v[100:103], v[56:59], v[244:247], v[100:103]
    ds_read_b128 v[56:59], v10 offset:16640
    s_waitcnt lgkmcnt(6)
    v_mfma_f32_16x16x32_bf16 v[96:99], v[60:63], v[248:251], v[96:99]
    v_mfma_f32_16x16x32_bf16 v[100:103], v[60:63], v[252:255], v[100:103]
    ds_read_b128 v[60:63], v11 offset:16640
    v_mfma_f32_16x16x32_bf16 v[104:107], v[32:35], v[128:131], v[24:27]
    v_mfma_f32_16x16x32_bf16 v[108:111], v[32:35], v[132:135], v[28:31]
    ds_read_b128 v[32:35], v8 offset:16896
    s_waitcnt lgkmcnt(6)
    v_mfma_f32_16x16x32_bf16 v[104:107], v[36:39], v[136:139], v[104:107]
    v_mfma_f32_16x16x32_bf16 v[108:111], v[36:39], v[140:143], v[108:111]
    ds_read_b128 v[36:39], v9 offset:16896
    v_mfma_f32_16x16x32_bf16 v[104:107], v[40:43], v[144:147], v[104:107]
    v_cvt_pk_bf16_f32 v64, v96, v100
    v_cvt_pk_bf16_f32 v65, v97, v101
    v_mfma_f32_16x16x32_bf16 v[108:111], v[40:43], v[148:151], v[108:111]
    ds_read_b128 v[40:43], v10 offset:16896
    s_waitcnt lgkmcnt(6)
    v_mfma_f32_16x16x32_bf16 v[104:107], v[44:47], v[152:155], v[104:107]
    v_cvt_pk_bf16_f32 v66, v98, v102
    v_cvt_pk_bf16_f32 v67, v99, v103
    v_mfma_f32_16x16x32_bf16 v[108:111], v[44:47], v[156:159], v[108:111]
    ds_read_b128 v[44:47], v11 offset:16896
    v_mfma_f32_16x16x32_bf16 v[104:107], v[48:51], v[160:163], v[104:107]
    v_mov_b32_dpp v16, v64 quad_perm:[1,0,3,2] row_mask:0xf bank_mask:0xf
    v_mov_b32_dpp v17, v65 quad_perm:[1,0,3,2] row_mask:0xf bank_mask:0xf
    v_mfma_f32_16x16x32_bf16 v[108:111], v[48:51], v[164:167], v[108:111]
    ds_read_b128 v[48:51], v8 offset:17152
    s_waitcnt lgkmcnt(6)
    v_mfma_f32_16x16x32_bf16 v[104:107], v[52:55], v[168:171], v[104:107]
    v_mov_b32_dpp v18, v66 quad_perm:[1,0,3,2] row_mask:0xf bank_mask:0xf
    v_mov_b32_dpp v19, v67 quad_perm:[1,0,3,2] row_mask:0xf bank_mask:0xf
    v_subrev_u32 v8, 0x20000, v8
    v_mfma_f32_16x16x32_bf16 v[108:111], v[52:55], v[172:175], v[108:111]
    ds_read_b128 v[52:55], v9 offset:17152
    v_mfma_f32_16x16x32_bf16 v[104:107], v[56:59], v[176:179], v[104:107]
    v_perm_b32 v64, v16, v64, v6
    v_perm_b32 v65, v17, v65, v6
    v_subrev_u32 v9, 0x20000, v9
    v_mfma_f32_16x16x32_bf16 v[108:111], v[56:59], v[180:183], v[108:111]
    ds_read_b128 v[56:59], v10 offset:17152
    s_waitcnt lgkmcnt(6)
    v_mfma_f32_16x16x32_bf16 v[104:107], v[60:63], v[184:187], v[104:107]
    v_perm_b32 v66, v18, v66, v6
    v_perm_b32 v67, v19, v67, v6
    v_subrev_u32 v10, 0x20000, v10
    v_mfma_f32_16x16x32_bf16 v[108:111], v[60:63], v[188:191], v[108:111]
    ds_read_b128 v[60:63], v11 offset:17152
    v_mfma_f32_16x16x32_bf16 v[104:107], v[32:35], v[192:195], v[104:107]
    buffer_store_dword v64, v7, s[20:23], s36 offen offset:0 nt
    v_subrev_u32 v11, 0x20000, v11
    v_mfma_f32_16x16x32_bf16 v[108:111], v[32:35], v[196:199], v[108:111]
    s_barrier
    ds_read_b128 v[32:35], v8 offset:0
    s_waitcnt lgkmcnt(6)
    v_mfma_f32_16x16x32_bf16 v[104:107], v[36:39], v[200:203], v[104:107]
    buffer_store_dword v65, v7, s[20:23], s36 offen offset:1024 nt
    v_mfma_f32_16x16x32_bf16 v[108:111], v[36:39], v[204:207], v[108:111]
    ds_read_b128 v[36:39], v9 offset:0
    v_mfma_f32_16x16x32_bf16 v[104:107], v[40:43], v[208:211], v[104:107]
    buffer_store_dword v66, v7, s[20:23], s36 offen offset:2048 nt
    v_mfma_f32_16x16x32_bf16 v[108:111], v[40:43], v[212:215], v[108:111]
    ds_read_b128 v[40:43], v10 offset:0
    s_waitcnt lgkmcnt(6)
    v_mfma_f32_16x16x32_bf16 v[104:107], v[44:47], v[216:219], v[104:107]
    buffer_store_dword v67, v7, s[20:23], s36 offen offset:3072 nt
    v_mfma_f32_16x16x32_bf16 v[108:111], v[44:47], v[220:223], v[108:111]
    ds_read_b128 v[44:47], v11 offset:0
    v_mfma_f32_16x16x32_bf16 v[104:107], v[48:51], v[224:227], v[104:107]
    v_mfma_f32_16x16x32_bf16 v[108:111], v[48:51], v[228:231], v[108:111]
    ds_read_b128 v[48:51], v8 offset:256
    s_waitcnt lgkmcnt(6)
    v_mfma_f32_16x16x32_bf16 v[104:107], v[52:55], v[232:235], v[104:107]
    v_mfma_f32_16x16x32_bf16 v[108:111], v[52:55], v[236:239], v[108:111]
    ds_read_b128 v[52:55], v9 offset:256
    v_mfma_f32_16x16x32_bf16 v[104:107], v[56:59], v[240:243], v[104:107]
    v_mfma_f32_16x16x32_bf16 v[108:111], v[56:59], v[244:247], v[108:111]
    ds_read_b128 v[56:59], v10 offset:256
    s_waitcnt lgkmcnt(6)
    v_mfma_f32_16x16x32_bf16 v[104:107], v[60:63], v[248:251], v[104:107]
    v_mfma_f32_16x16x32_bf16 v[108:111], v[60:63], v[252:255], v[108:111]
    ds_read_b128 v[60:63], v11 offset:256
    v_mfma_f32_16x16x32_bf16 v[112:115], v[32:35], v[128:131], v[24:27]
    v_mfma_f32_16x16x32_bf16 v[116:119], v[32:35], v[132:135], v[28:31]
    ds_read_b128 v[32:35], v8 offset:512
    s_waitcnt lgkmcnt(6)
    v_mfma_f32_16x16x32_bf16 v[112:115], v[36:39], v[136:139], v[112:115]
    v_mfma_f32_16x16x32_bf16 v[116:119], v[36:39], v[140:143], v[116:119]
    ds_read_b128 v[36:39], v9 offset:512
    v_mfma_f32_16x16x32_bf16 v[112:115], v[40:43], v[144:147], v[112:115]
    v_cvt_pk_bf16_f32 v68, v104, v108
    v_cvt_pk_bf16_f32 v69, v105, v109
    v_mfma_f32_16x16x32_bf16 v[116:119], v[40:43], v[148:151], v[116:119]
    ds_read_b128 v[40:43], v10 offset:512
    s_waitcnt lgkmcnt(6)
    v_mfma_f32_16x16x32_bf16 v[112:115], v[44:47], v[152:155], v[112:115]
    v_cvt_pk_bf16_f32 v70, v106, v110
    v_cvt_pk_bf16_f32 v71, v107, v111
    v_mfma_f32_16x16x32_bf16 v[116:119], v[44:47], v[156:159], v[116:119]
    ds_read_b128 v[44:47], v11 offset:512
    v_mfma_f32_16x16x32_bf16 v[112:115], v[48:51], v[160:163], v[112:115]
    v_mov_b32_dpp v16, v68 quad_perm:[1,0,3,2] row_mask:0xf bank_mask:0xf
    v_mov_b32_dpp v17, v69 quad_perm:[1,0,3,2] row_mask:0xf bank_mask:0xf
    v_mfma_f32_16x16x32_bf16 v[116:119], v[48:51], v[164:167], v[116:119]
    ds_read_b128 v[48:51], v8 offset:768
    s_waitcnt lgkmcnt(6)
    v_mfma_f32_16x16x32_bf16 v[112:115], v[52:55], v[168:171], v[112:115]
    v_mov_b32_dpp v18, v70 quad_perm:[1,0,3,2] row_mask:0xf bank_mask:0xf
    v_mov_b32_dpp v19, v71 quad_perm:[1,0,3,2] row_mask:0xf bank_mask:0xf
    v_mfma_f32_16x16x32_bf16 v[116:119], v[52:55], v[172:175], v[116:119]
    ds_read_b128 v[52:55], v9 offset:768
    v_mfma_f32_16x16x32_bf16 v[112:115], v[56:59], v[176:179], v[112:115]
    v_perm_b32 v68, v16, v68, v6
    v_perm_b32 v69, v17, v69, v6
    v_mfma_f32_16x16x32_bf16 v[116:119], v[56:59], v[180:183], v[116:119]
    ds_read_b128 v[56:59], v10 offset:768
    s_waitcnt lgkmcnt(6)
    v_mfma_f32_16x16x32_bf16 v[112:115], v[60:63], v[184:187], v[112:115]
    v_perm_b32 v70, v18, v70, v6
    v_perm_b32 v71, v19, v71, v6
    v_mfma_f32_16x16x32_bf16 v[116:119], v[60:63], v[188:191], v[116:119]
    ds_read_b128 v[60:63], v11 offset:768
    v_mfma_f32_16x16x32_bf16 v[112:115], v[32:35], v[192:195], v[112:115]
    s_add_u32 s5, s36, 0x4000
    buffer_store_dword v68, v7, s[20:23], s5 offen offset:0 nt
    v_mfma_f32_16x16x32_bf16 v[116:119], v[32:35], v[196:199], v[116:119]
    ds_read_b128 v[32:35], v8 offset:16384
    s_waitcnt lgkmcnt(6)
    v_mfma_f32_16x16x32_bf16 v[112:115], v[36:39], v[200:203], v[112:115]
    buffer_store_dword v69, v7, s[20:23], s5 offen offset:1024 nt
    v_mfma_f32_16x16x32_bf16 v[116:119], v[36:39], v[204:207], v[116:119]
    ds_read_b128 v[36:39], v9 offset:16384
    v_mfma_f32_16x16x32_bf16 v[112:115], v[40:43], v[208:211], v[112:115]
    buffer_store_dword v70, v7, s[20:23], s5 offen offset:2048 nt
    v_mfma_f32_16x16x32_bf16 v[116:119], v[40:43], v[212:215], v[116:119]
    ds_read_b128 v[40:43], v10 offset:16384
    s_waitcnt lgkmcnt(6)
    v_mfma_f32_16x16x32_bf16 v[112:115], v[44:47], v[216:219], v[112:115]
    buffer_store_dword v71, v7, s[20:23], s5 offen offset:3072 nt
    v_mfma_f32_16x16x32_bf16 v[116:119], v[44:47], v[220:223], v[116:119]
    ds_read_b128 v[44:47], v11 offset:16384
    v_mfma_f32_16x16x32_bf16 v[112:115], v[48:51], v[224:227], v[112:115]
    v_mfma_f32_16x16x32_bf16 v[116:119], v[48:51], v[228:231], v[116:119]
    ds_read_b128 v[48:51], v8 offset:16640
    s_waitcnt lgkmcnt(6)
    v_mfma_f32_16x16x32_bf16 v[112:115], v[52:55], v[232:235], v[112:115]
    v_mfma_f32_16x16x32_bf16 v[116:119], v[52:55], v[236:239], v[116:119]
    ds_read_b128 v[52:55], v9 offset:16640
    v_mfma_f32_16x16x32_bf16 v[112:115], v[56:59], v[240:243], v[112:115]
    v_mfma_f32_16x16x32_bf16 v[116:119], v[56:59], v[244:247], v[116:119]
    ds_read_b128 v[56:59], v10 offset:16640
    s_waitcnt lgkmcnt(6)
    v_mfma_f32_16x16x32_bf16 v[112:115], v[60:63], v[248:251], v[112:115]
    v_mfma_f32_16x16x32_bf16 v[116:119], v[60:63], v[252:255], v[116:119]
    ds_read_b128 v[60:63], v11 offset:16640
    v_mfma_f32_16x16x32_bf16 v[120:123], v[32:35], v[128:131], v[24:27]
    v_mfma_f32_16x16x32_bf16 v[124:127], v[32:35], v[132:135], v[28:31]
    ds_read_b128 v[32:35], v8 offset:16896
    s_waitcnt lgkmcnt(6)
    v_mfma_f32_16x16x32_bf16 v[120:123], v[36:39], v[136:139], v[120:123]
    v_mfma_f32_16x16x32_bf16 v[124:127], v[36:39], v[140:143], v[124:127]
    ds_read_b128 v[36:39], v9 offset:16896
    v_mfma_f32_16x16x32_bf16 v[120:123], v[40:43], v[144:147], v[120:123]
    v_cvt_pk_bf16_f32 v72, v112, v116
    v_cvt_pk_bf16_f32 v73, v113, v117
    v_mfma_f32_16x16x32_bf16 v[124:127], v[40:43], v[148:151], v[124:127]
    ds_read_b128 v[40:43], v10 offset:16896
    s_waitcnt lgkmcnt(6)
    v_mfma_f32_16x16x32_bf16 v[120:123], v[44:47], v[152:155], v[120:123]
    v_cvt_pk_bf16_f32 v74, v114, v118
    v_cvt_pk_bf16_f32 v75, v115, v119
    v_mfma_f32_16x16x32_bf16 v[124:127], v[44:47], v[156:159], v[124:127]
    ds_read_b128 v[44:47], v11 offset:16896
    v_mfma_f32_16x16x32_bf16 v[120:123], v[48:51], v[160:163], v[120:123]
    v_mov_b32_dpp v16, v72 quad_perm:[1,0,3,2] row_mask:0xf bank_mask:0xf
    v_mov_b32_dpp v17, v73 quad_perm:[1,0,3,2] row_mask:0xf bank_mask:0xf
    v_mfma_f32_16x16x32_bf16 v[124:127], v[48:51], v[164:167], v[124:127]
    ds_read_b128 v[48:51], v8 offset:17152
    s_waitcnt lgkmcnt(6)
    v_mfma_f32_16x16x32_bf16 v[120:123], v[52:55], v[168:171], v[120:123]
    v_mov_b32_dpp v18, v74 quad_perm:[1,0,3,2] row_mask:0xf bank_mask:0xf
    v_mov_b32_dpp v19, v75 quad_perm:[1,0,3,2] row_mask:0xf bank_mask:0xf
    v_add_u32 v8, 0x8000, v8
    v_mfma_f32_16x16x32_bf16 v[124:127], v[52:55], v[172:175], v[124:127]
    ds_read_b128 v[52:55], v9 offset:17152
    v_mfma_f32_16x16x32_bf16 v[120:123], v[56:59], v[176:179], v[120:123]
    v_perm_b32 v72, v16, v72, v6
    v_perm_b32 v73, v17, v73, v6
    v_add_u32 v9, 0x8000, v9
    v_mfma_f32_16x16x32_bf16 v[124:127], v[56:59], v[180:183], v[124:127]
    ds_read_b128 v[56:59], v10 offset:17152
    s_waitcnt lgkmcnt(6)
    v_mfma_f32_16x16x32_bf16 v[120:123], v[60:63], v[184:187], v[120:123]
    v_perm_b32 v74, v18, v74, v6
    v_perm_b32 v75, v19, v75, v6
    v_add_u32 v10, 0x8000, v10
    v_mfma_f32_16x16x32_bf16 v[124:127], v[60:63], v[188:191], v[124:127]
    ds_read_b128 v[60:63], v11 offset:17152
    v_mfma_f32_16x16x32_bf16 v[120:123], v[32:35], v[192:195], v[120:123]
    buffer_store_dword v72, v7, s[20:23], s37 offen offset:0 nt
    v_add_u32 v11, 0x8000, v11
    v_mfma_f32_16x16x32_bf16 v[124:127], v[32:35], v[196:199], v[124:127]
    s_barrier
    ds_read_b128 v[32:35], v8 offset:0
    s_waitcnt lgkmcnt(6)
    v_mfma_f32_16x16x32_bf16 v[120:123], v[36:39], v[200:203], v[120:123]
    buffer_store_dword v73, v7, s[20:23], s37 offen offset:1024 nt
    v_mfma_f32_16x16x32_bf16 v[124:127], v[36:39], v[204:207], v[124:127]
    ds_read_b128 v[36:39], v9 offset:0
    v_mfma_f32_16x16x32_bf16 v[120:123], v[40:43], v[208:211], v[120:123]
    buffer_store_dword v74, v7, s[20:23], s37 offen offset:2048 nt
    v_mfma_f32_16x16x32_bf16 v[124:127], v[40:43], v[212:215], v[124:127]
    ds_read_b128 v[40:43], v10 offset:0
    s_waitcnt lgkmcnt(6)
    v_mfma_f32_16x16x32_bf16 v[120:123], v[44:47], v[216:219], v[120:123]
    buffer_store_dword v75, v7, s[20:23], s37 offen offset:3072 nt
    v_mfma_f32_16x16x32_bf16 v[124:127], v[44:47], v[220:223], v[124:127]
    ds_read_b128 v[44:47], v11 offset:0
    v_mfma_f32_16x16x32_bf16 v[120:123], v[48:51], v[224:227], v[120:123]
    v_mfma_f32_16x16x32_bf16 v[124:127], v[48:51], v[228:231], v[124:127]
    ds_read_b128 v[48:51], v8 offset:256
    s_waitcnt lgkmcnt(6)
    v_mfma_f32_16x16x32_bf16 v[120:123], v[52:55], v[232:235], v[120:123]
    v_mfma_f32_16x16x32_bf16 v[124:127], v[52:55], v[236:239], v[124:127]
    ds_read_b128 v[52:55], v9 offset:256
    v_mfma_f32_16x16x32_bf16 v[120:123], v[56:59], v[240:243], v[120:123]
    v_mfma_f32_16x16x32_bf16 v[124:127], v[56:59], v[244:247], v[124:127]
    ds_read_b128 v[56:59], v10 offset:256
    s_waitcnt lgkmcnt(6)
    v_mfma_f32_16x16x32_bf16 v[120:123], v[60:63], v[248:251], v[120:123]
    v_mfma_f32_16x16x32_bf16 v[124:127], v[60:63], v[252:255], v[124:127]
    ds_read_b128 v[60:63], v11 offset:256
    v_mfma_f32_16x16x32_bf16 v[96:99], v[32:35], v[128:131], v[24:27]
    v_mfma_f32_16x16x32_bf16 v[100:103], v[32:35], v[132:135], v[28:31]
    ds_read_b128 v[32:35], v8 offset:512
    s_waitcnt lgkmcnt(6)
    v_mfma_f32_16x16x32_bf16 v[96:99], v[36:39], v[136:139], v[96:99]
    v_mfma_f32_16x16x32_bf16 v[100:103], v[36:39], v[140:143], v[100:103]
    ds_read_b128 v[36:39], v9 offset:512
    v_mfma_f32_16x16x32_bf16 v[96:99], v[40:43], v[144:147], v[96:99]
    v_cvt_pk_bf16_f32 v76, v120, v124
    v_cvt_pk_bf16_f32 v77, v121, v125
    v_mfma_f32_16x16x32_bf16 v[100:103], v[40:43], v[148:151], v[100:103]
    ds_read_b128 v[40:43], v10 offset:512
    s_waitcnt lgkmcnt(6)
    v_mfma_f32_16x16x32_bf16 v[96:99], v[44:47], v[152:155], v[96:99]
    v_cvt_pk_bf16_f32 v78, v122, v126
    v_cvt_pk_bf16_f32 v79, v123, v127
    v_mfma_f32_16x16x32_bf16 v[100:103], v[44:47], v[156:159], v[100:103]
    ds_read_b128 v[44:47], v11 offset:512
    v_mfma_f32_16x16x32_bf16 v[96:99], v[48:51], v[160:163], v[96:99]
    v_mov_b32_dpp v16, v76 quad_perm:[1,0,3,2] row_mask:0xf bank_mask:0xf
    v_mov_b32_dpp v17, v77 quad_perm:[1,0,3,2] row_mask:0xf bank_mask:0xf
    v_mfma_f32_16x16x32_bf16 v[100:103], v[48:51], v[164:167], v[100:103]
    ds_read_b128 v[48:51], v8 offset:768
    s_waitcnt lgkmcnt(6)
    v_mfma_f32_16x16x32_bf16 v[96:99], v[52:55], v[168:171], v[96:99]
    v_mov_b32_dpp v18, v78 quad_perm:[1,0,3,2] row_mask:0xf bank_mask:0xf
    v_mov_b32_dpp v19, v79 quad_perm:[1,0,3,2] row_mask:0xf bank_mask:0xf
    v_mfma_f32_16x16x32_bf16 v[100:103], v[52:55], v[172:175], v[100:103]
    ds_read_b128 v[52:55], v9 offset:768
    v_mfma_f32_16x16x32_bf16 v[96:99], v[56:59], v[176:179], v[96:99]
    v_perm_b32 v76, v16, v76, v6
    v_perm_b32 v77, v17, v77, v6
    v_mfma_f32_16x16x32_bf16 v[100:103], v[56:59], v[180:183], v[100:103]
    ds_read_b128 v[56:59], v10 offset:768
    s_waitcnt lgkmcnt(6)
    v_mfma_f32_16x16x32_bf16 v[96:99], v[60:63], v[184:187], v[96:99]
    v_perm_b32 v78, v18, v78, v6
    v_perm_b32 v79, v19, v79, v6
    v_mfma_f32_16x16x32_bf16 v[100:103], v[60:63], v[188:191], v[100:103]
    ds_read_b128 v[60:63], v11 offset:768
    v_mfma_f32_16x16x32_bf16 v[96:99], v[32:35], v[192:195], v[96:99]
    s_add_u32 s5, s37, 0x4000
    buffer_store_dword v76, v7, s[20:23], s5 offen offset:0 nt
    v_mfma_f32_16x16x32_bf16 v[100:103], v[32:35], v[196:199], v[100:103]
    ds_read_b128 v[32:35], v8 offset:16384
    s_waitcnt lgkmcnt(6)
    v_mfma_f32_16x16x32_bf16 v[96:99], v[36:39], v[200:203], v[96:99]
    buffer_store_dword v77, v7, s[20:23], s5 offen offset:1024 nt
    v_mfma_f32_16x16x32_bf16 v[100:103], v[36:39], v[204:207], v[100:103]
    ds_read_b128 v[36:39], v9 offset:16384
    v_mfma_f32_16x16x32_bf16 v[96:99], v[40:43], v[208:211], v[96:99]
    buffer_store_dword v78, v7, s[20:23], s5 offen offset:2048 nt
    v_mfma_f32_16x16x32_bf16 v[100:103], v[40:43], v[212:215], v[100:103]
    ds_read_b128 v[40:43], v10 offset:16384
    s_waitcnt lgkmcnt(6)
    v_mfma_f32_16x16x32_bf16 v[96:99], v[44:47], v[216:219], v[96:99]
    buffer_store_dword v79, v7, s[20:23], s5 offen offset:3072 nt
    v_mfma_f32_16x16x32_bf16 v[100:103], v[44:47], v[220:223], v[100:103]
    ds_read_b128 v[44:47], v11 offset:16384
    v_mfma_f32_16x16x32_bf16 v[96:99], v[48:51], v[224:227], v[96:99]
    v_mfma_f32_16x16x32_bf16 v[100:103], v[48:51], v[228:231], v[100:103]
    ds_read_b128 v[48:51], v8 offset:16640
    s_waitcnt lgkmcnt(6)
    v_mfma_f32_16x16x32_bf16 v[96:99], v[52:55], v[232:235], v[96:99]
    v_mfma_f32_16x16x32_bf16 v[100:103], v[52:55], v[236:239], v[100:103]
    ds_read_b128 v[52:55], v9 offset:16640
    v_mfma_f32_16x16x32_bf16 v[96:99], v[56:59], v[240:243], v[96:99]
    v_mfma_f32_16x16x32_bf16 v[100:103], v[56:59], v[244:247], v[100:103]
    ds_read_b128 v[56:59], v10 offset:16640
    s_waitcnt lgkmcnt(6)
    v_mfma_f32_16x16x32_bf16 v[96:99], v[60:63], v[248:251], v[96:99]
    v_mfma_f32_16x16x32_bf16 v[100:103], v[60:63], v[252:255], v[100:103]
    ds_read_b128 v[60:63], v11 offset:16640
    v_mfma_f32_16x16x32_bf16 v[104:107], v[32:35], v[128:131], v[24:27]
    v_mfma_f32_16x16x32_bf16 v[108:111], v[32:35], v[132:135], v[28:31]
    ds_read_b128 v[32:35], v8 offset:16896
    s_waitcnt lgkmcnt(6)
    v_mfma_f32_16x16x32_bf16 v[104:107], v[36:39], v[136:139], v[104:107]
    v_mfma_f32_16x16x32_bf16 v[108:111], v[36:39], v[140:143], v[108:111]
    ds_read_b128 v[36:39], v9 offset:16896
    v_mfma_f32_16x16x32_bf16 v[104:107], v[40:43], v[144:147], v[104:107]
    v_cvt_pk_bf16_f32 v80, v96, v100
    v_cvt_pk_bf16_f32 v81, v97, v101
    v_mfma_f32_16x16x32_bf16 v[108:111], v[40:43], v[148:151], v[108:111]
    ds_read_b128 v[40:43], v10 offset:16896
    s_waitcnt lgkmcnt(6)
    v_mfma_f32_16x16x32_bf16 v[104:107], v[44:47], v[152:155], v[104:107]
    v_cvt_pk_bf16_f32 v82, v98, v102
    v_cvt_pk_bf16_f32 v83, v99, v103
    v_mfma_f32_16x16x32_bf16 v[108:111], v[44:47], v[156:159], v[108:111]
    ds_read_b128 v[44:47], v11 offset:16896
    v_mfma_f32_16x16x32_bf16 v[104:107], v[48:51], v[160:163], v[104:107]
    v_mov_b32_dpp v16, v80 quad_perm:[1,0,3,2] row_mask:0xf bank_mask:0xf
    v_mov_b32_dpp v17, v81 quad_perm:[1,0,3,2] row_mask:0xf bank_mask:0xf
    v_mfma_f32_16x16x32_bf16 v[108:111], v[48:51], v[164:167], v[108:111]
    ds_read_b128 v[48:51], v8 offset:17152
    s_waitcnt lgkmcnt(6)
    v_mfma_f32_16x16x32_bf16 v[104:107], v[52:55], v[168:171], v[104:107]
    v_mov_b32_dpp v18, v82 quad_perm:[1,0,3,2] row_mask:0xf bank_mask:0xf
    v_mov_b32_dpp v19, v83 quad_perm:[1,0,3,2] row_mask:0xf bank_mask:0xf
    v_add_u32 v8, 0x8000, v8
    v_mfma_f32_16x16x32_bf16 v[108:111], v[52:55], v[172:175], v[108:111]
    ds_read_b128 v[52:55], v9 offset:17152
    v_mfma_f32_16x16x32_bf16 v[104:107], v[56:59], v[176:179], v[104:107]
    v_perm_b32 v80, v16, v80, v6
    v_perm_b32 v81, v17, v81, v6
    v_add_u32 v9, 0x8000, v9
    v_mfma_f32_16x16x32_bf16 v[108:111], v[56:59], v[180:183], v[108:111]
    ds_read_b128 v[56:59], v10 offset:17152
    s_waitcnt lgkmcnt(6)
    v_mfma_f32_16x16x32_bf16 v[104:107], v[60:63], v[184:187], v[104:107]
    v_perm_b32 v82, v18, v82, v6
    v_perm_b32 v83, v19, v83, v6
    v_add_u32 v10, 0x8000, v10
    v_mfma_f32_16x16x32_bf16 v[108:111], v[60:63], v[188:191], v[108:111]
    ds_read_b128 v[60:63], v11 offset:17152
    v_mfma_f32_16x16x32_bf16 v[104:107], v[32:35], v[192:195], v[104:107]
    buffer_store_dword v80, v7, s[20:23], s38 offen offset:0 nt
    v_add_u32 v11, 0x8000, v11
    v_mfma_f32_16x16x32_bf16 v[108:111], v[32:35], v[196:199], v[108:111]
    s_barrier
    ds_read_b128 v[32:35], v8 offset:0
    s_waitcnt lgkmcnt(6)
    v_mfma_f32_16x16x32_bf16 v[104:107], v[36:39], v[200:203], v[104:107]
    buffer_store_dword v81, v7, s[20:23], s38 offen offset:1024 nt
    v_mfma_f32_16x16x32_bf16 v[108:111], v[36:39], v[204:207], v[108:111]
    ds_read_b128 v[36:39], v9 offset:0
    v_mfma_f32_16x16x32_bf16 v[104:107], v[40:43], v[208:211], v[104:107]
    buffer_store_dword v82, v7, s[20:23], s38 offen offset:2048 nt
    v_mfma_f32_16x16x32_bf16 v[108:111], v[40:43], v[212:215], v[108:111]
    ds_read_b128 v[40:43], v10 offset:0
    s_waitcnt lgkmcnt(6)
    v_mfma_f32_16x16x32_bf16 v[104:107], v[44:47], v[216:219], v[104:107]
    buffer_store_dword v83, v7, s[20:23], s38 offen offset:3072 nt
    v_mfma_f32_16x16x32_bf16 v[108:111], v[44:47], v[220:223], v[108:111]
    ds_read_b128 v[44:47], v11 offset:0
    v_mfma_f32_16x16x32_bf16 v[104:107], v[48:51], v[224:227], v[104:107]
    v_mfma_f32_16x16x32_bf16 v[108:111], v[48:51], v[228:231], v[108:111]
    ds_read_b128 v[48:51], v8 offset:256
    s_waitcnt lgkmcnt(6)
    v_mfma_f32_16x16x32_bf16 v[104:107], v[52:55], v[232:235], v[104:107]
    v_mfma_f32_16x16x32_bf16 v[108:111], v[52:55], v[236:239], v[108:111]
    ds_read_b128 v[52:55], v9 offset:256
    v_mfma_f32_16x16x32_bf16 v[104:107], v[56:59], v[240:243], v[104:107]
    v_mfma_f32_16x16x32_bf16 v[108:111], v[56:59], v[244:247], v[108:111]
    ds_read_b128 v[56:59], v10 offset:256
    s_waitcnt lgkmcnt(6)
    v_mfma_f32_16x16x32_bf16 v[104:107], v[60:63], v[248:251], v[104:107]
    v_mfma_f32_16x16x32_bf16 v[108:111], v[60:63], v[252:255], v[108:111]
    ds_read_b128 v[60:63], v11 offset:256
    v_mfma_f32_16x16x32_bf16 v[112:115], v[32:35], v[128:131], v[24:27]
    v_mfma_f32_16x16x32_bf16 v[116:119], v[32:35], v[132:135], v[28:31]
    ds_read_b128 v[32:35], v8 offset:512
    s_waitcnt lgkmcnt(6)
    v_mfma_f32_16x16x32_bf16 v[112:115], v[36:39], v[136:139], v[112:115]
    v_mfma_f32_16x16x32_bf16 v[116:119], v[36:39], v[140:143], v[116:119]
    ds_read_b128 v[36:39], v9 offset:512
    v_mfma_f32_16x16x32_bf16 v[112:115], v[40:43], v[144:147], v[112:115]
    v_cvt_pk_bf16_f32 v84, v104, v108
    v_cvt_pk_bf16_f32 v85, v105, v109
    v_mfma_f32_16x16x32_bf16 v[116:119], v[40:43], v[148:151], v[116:119]
    ds_read_b128 v[40:43], v10 offset:512
    s_waitcnt lgkmcnt(6)
    v_mfma_f32_16x16x32_bf16 v[112:115], v[44:47], v[152:155], v[112:115]
    v_cvt_pk_bf16_f32 v86, v106, v110
    v_cvt_pk_bf16_f32 v87, v107, v111
    v_mfma_f32_16x16x32_bf16 v[116:119], v[44:47], v[156:159], v[116:119]
    ds_read_b128 v[44:47], v11 offset:512
    v_mfma_f32_16x16x32_bf16 v[112:115], v[48:51], v[160:163], v[112:115]
    v_mov_b32_dpp v16, v84 quad_perm:[1,0,3,2] row_mask:0xf bank_mask:0xf
    v_mov_b32_dpp v17, v85 quad_perm:[1,0,3,2] row_mask:0xf bank_mask:0xf
    v_mfma_f32_16x16x32_bf16 v[116:119], v[48:51], v[164:167], v[116:119]
    ds_read_b128 v[48:51], v8 offset:768
    s_waitcnt lgkmcnt(6)
    v_mfma_f32_16x16x32_bf16 v[112:115], v[52:55], v[168:171], v[112:115]
    v_mov_b32_dpp v18, v86 quad_perm:[1,0,3,2] row_mask:0xf bank_mask:0xf
    v_mov_b32_dpp v19, v87 quad_perm:[1,0,3,2] row_mask:0xf bank_mask:0xf
    v_mfma_f32_16x16x32_bf16 v[116:119], v[52:55], v[172:175], v[116:119]
    ds_read_b128 v[52:55], v9 offset:768
    v_mfma_f32_16x16x32_bf16 v[112:115], v[56:59], v[176:179], v[112:115]
    v_perm_b32 v84, v16, v84, v6
    v_perm_b32 v85, v17, v85, v6
    v_mfma_f32_16x16x32_bf16 v[116:119], v[56:59], v[180:183], v[116:119]
    ds_read_b128 v[56:59], v10 offset:768
    s_waitcnt lgkmcnt(6)
    v_mfma_f32_16x16x32_bf16 v[112:115], v[60:63], v[184:187], v[112:115]
    v_perm_b32 v86, v18, v86, v6
    v_perm_b32 v87, v19, v87, v6
    v_mfma_f32_16x16x32_bf16 v[116:119], v[60:63], v[188:191], v[116:119]
    ds_read_b128 v[60:63], v11 offset:768
    v_mfma_f32_16x16x32_bf16 v[112:115], v[32:35], v[192:195], v[112:115]
    s_add_u32 s5, s38, 0x4000
    buffer_store_dword v84, v7, s[20:23], s5 offen offset:0 nt
    v_mfma_f32_16x16x32_bf16 v[116:119], v[32:35], v[196:199], v[116:119]
    ds_read_b128 v[32:35], v8 offset:16384
    s_waitcnt lgkmcnt(6)
    v_mfma_f32_16x16x32_bf16 v[112:115], v[36:39], v[200:203], v[112:115]
    buffer_store_dword v85, v7, s[20:23], s5 offen offset:1024 nt
    v_mfma_f32_16x16x32_bf16 v[116:119], v[36:39], v[204:207], v[116:119]
    ds_read_b128 v[36:39], v9 offset:16384
    v_mfma_f32_16x16x32_bf16 v[112:115], v[40:43], v[208:211], v[112:115]
    buffer_store_dword v86, v7, s[20:23], s5 offen offset:2048 nt
    v_mfma_f32_16x16x32_bf16 v[116:119], v[40:43], v[212:215], v[116:119]
    ds_read_b128 v[40:43], v10 offset:16384
    s_waitcnt lgkmcnt(6)
    v_mfma_f32_16x16x32_bf16 v[112:115], v[44:47], v[216:219], v[112:115]
    buffer_store_dword v87, v7, s[20:23], s5 offen offset:3072 nt
    v_mfma_f32_16x16x32_bf16 v[116:119], v[44:47], v[220:223], v[116:119]
    ds_read_b128 v[44:47], v11 offset:16384
    v_mfma_f32_16x16x32_bf16 v[112:115], v[48:51], v[224:227], v[112:115]
    v_mfma_f32_16x16x32_bf16 v[116:119], v[48:51], v[228:231], v[116:119]
    ds_read_b128 v[48:51], v8 offset:16640
    s_waitcnt lgkmcnt(6)
    v_mfma_f32_16x16x32_bf16 v[112:115], v[52:55], v[232:235], v[112:115]
    v_mfma_f32_16x16x32_bf16 v[116:119], v[52:55], v[236:239], v[116:119]
    ds_read_b128 v[52:55], v9 offset:16640
    v_mfma_f32_16x16x32_bf16 v[112:115], v[56:59], v[240:243], v[112:115]
    v_mfma_f32_16x16x32_bf16 v[116:119], v[56:59], v[244:247], v[116:119]
    ds_read_b128 v[56:59], v10 offset:16640
    s_waitcnt lgkmcnt(6)
    v_mfma_f32_16x16x32_bf16 v[112:115], v[60:63], v[248:251], v[112:115]
    v_mfma_f32_16x16x32_bf16 v[116:119], v[60:63], v[252:255], v[116:119]
    ds_read_b128 v[60:63], v11 offset:16640
    v_mfma_f32_16x16x32_bf16 v[120:123], v[32:35], v[128:131], v[24:27]
    v_mfma_f32_16x16x32_bf16 v[124:127], v[32:35], v[132:135], v[28:31]
    ds_read_b128 v[32:35], v8 offset:16896
    s_waitcnt lgkmcnt(6)
    v_mfma_f32_16x16x32_bf16 v[120:123], v[36:39], v[136:139], v[120:123]
    v_mfma_f32_16x16x32_bf16 v[124:127], v[36:39], v[140:143], v[124:127]
    ds_read_b128 v[36:39], v9 offset:16896
    v_mfma_f32_16x16x32_bf16 v[120:123], v[40:43], v[144:147], v[120:123]
    v_cvt_pk_bf16_f32 v88, v112, v116
    v_cvt_pk_bf16_f32 v89, v113, v117
    v_mfma_f32_16x16x32_bf16 v[124:127], v[40:43], v[148:151], v[124:127]
    ds_read_b128 v[40:43], v10 offset:16896
    s_waitcnt lgkmcnt(6)
    v_mfma_f32_16x16x32_bf16 v[120:123], v[44:47], v[152:155], v[120:123]
    v_cvt_pk_bf16_f32 v90, v114, v118
    v_cvt_pk_bf16_f32 v91, v115, v119
    v_mfma_f32_16x16x32_bf16 v[124:127], v[44:47], v[156:159], v[124:127]
    ds_read_b128 v[44:47], v11 offset:16896
    v_mfma_f32_16x16x32_bf16 v[120:123], v[48:51], v[160:163], v[120:123]
    v_mov_b32_dpp v16, v88 quad_perm:[1,0,3,2] row_mask:0xf bank_mask:0xf
    v_mov_b32_dpp v17, v89 quad_perm:[1,0,3,2] row_mask:0xf bank_mask:0xf
    v_mfma_f32_16x16x32_bf16 v[124:127], v[48:51], v[164:167], v[124:127]
    ds_read_b128 v[48:51], v8 offset:17152
    s_waitcnt lgkmcnt(6)
    v_mfma_f32_16x16x32_bf16 v[120:123], v[52:55], v[168:171], v[120:123]
    v_mov_b32_dpp v18, v90 quad_perm:[1,0,3,2] row_mask:0xf bank_mask:0xf
    v_mov_b32_dpp v19, v91 quad_perm:[1,0,3,2] row_mask:0xf bank_mask:0xf
    v_mfma_f32_16x16x32_bf16 v[124:127], v[52:55], v[172:175], v[124:127]
    ds_read_b128 v[52:55], v9 offset:17152
    v_mfma_f32_16x16x32_bf16 v[120:123], v[56:59], v[176:179], v[120:123]
    v_perm_b32 v88, v16, v88, v6
    v_perm_b32 v89, v17, v89, v6
    v_mfma_f32_16x16x32_bf16 v[124:127], v[56:59], v[180:183], v[124:127]
    ds_read_b128 v[56:59], v10 offset:17152
    s_waitcnt lgkmcnt(6)
    v_mfma_f32_16x16x32_bf16 v[120:123], v[60:63], v[184:187], v[120:123]
    v_perm_b32 v90, v18, v90, v6
    v_perm_b32 v91, v19, v91, v6
    v_mfma_f32_16x16x32_bf16 v[124:127], v[60:63], v[188:191], v[124:127]
    ds_read_b128 v[60:63], v11 offset:17152
    v_mfma_f32_16x16x32_bf16 v[120:123], v[32:35], v[192:195], v[120:123]
    buffer_store_dword v88, v7, s[20:23], s39 offen offset:0 nt
    v_mfma_f32_16x16x32_bf16 v[124:127], v[32:35], v[196:199], v[124:127]
    s_waitcnt lgkmcnt(5)
    v_mfma_f32_16x16x32_bf16 v[120:123], v[36:39], v[200:203], v[120:123]
    buffer_store_dword v89, v7, s[20:23], s39 offen offset:1024 nt
    v_mfma_f32_16x16x32_bf16 v[124:127], v[36:39], v[204:207], v[124:127]
    v_mfma_f32_16x16x32_bf16 v[120:123], v[40:43], v[208:211], v[120:123]
    buffer_store_dword v90, v7, s[20:23], s39 offen offset:2048 nt
    v_mfma_f32_16x16x32_bf16 v[124:127], v[40:43], v[212:215], v[124:127]
    s_waitcnt lgkmcnt(3)
    v_mfma_f32_16x16x32_bf16 v[120:123], v[44:47], v[216:219], v[120:123]
    buffer_store_dword v91, v7, s[20:23], s39 offen offset:3072 nt
    v_mfma_f32_16x16x32_bf16 v[124:127], v[44:47], v[220:223], v[124:127]
    v_mfma_f32_16x16x32_bf16 v[120:123], v[48:51], v[224:227], v[120:123]
    v_mfma_f32_16x16x32_bf16 v[124:127], v[48:51], v[228:231], v[124:127]
    s_waitcnt lgkmcnt(1)
    v_mfma_f32_16x16x32_bf16 v[120:123], v[52:55], v[232:235], v[120:123]
    v_mfma_f32_16x16x32_bf16 v[124:127], v[52:55], v[236:239], v[124:127]
    v_mfma_f32_16x16x32_bf16 v[120:123], v[56:59], v[240:243], v[120:123]
    v_mfma_f32_16x16x32_bf16 v[124:127], v[56:59], v[244:247], v[124:127]
    s_waitcnt lgkmcnt(0)
    v_mfma_f32_16x16x32_bf16 v[120:123], v[60:63], v[248:251], v[120:123]
    v_mfma_f32_16x16x32_bf16 v[124:127], v[60:63], v[252:255], v[124:127]
    s_nop 7
    v_cvt_pk_bf16_f32 v92, v120, v124
    v_cvt_pk_bf16_f32 v93, v121, v125
    v_cvt_pk_bf16_f32 v94, v122, v126
    v_cvt_pk_bf16_f32 v95, v123, v127
    v_mov_b32_dpp v16, v92 quad_perm:[1,0,3,2] row_mask:0xf bank_mask:0xf
    v_mov_b32_dpp v17, v93 quad_perm:[1,0,3,2] row_mask:0xf bank_mask:0xf
    v_mov_b32_dpp v18, v94 quad_perm:[1,0,3,2] row_mask:0xf bank_mask:0xf
    v_mov_b32_dpp v19, v95 quad_perm:[1,0,3,2] row_mask:0xf bank_mask:0xf
    v_perm_b32 v92, v16, v92, v6
    v_perm_b32 v93, v17, v93, v6
    v_perm_b32 v94, v18, v94, v6
    v_perm_b32 v95, v19, v95, v6
    s_add_u32 s5, s39, 0x4000
    buffer_store_dword v92, v7, s[20:23], s5 offen offset:0 nt
    buffer_store_dword v93, v7, s[20:23], s5 offen offset:1024 nt
    buffer_store_dword v94, v7, s[20:23], s5 offen offset:2048 nt
    buffer_store_dword v95, v7, s[20:23], s5 offen offset:3072 nt
    s_endpgm
L_B:
    s_setprio 2
    s_waitcnt vmcnt(4)
    v_or_b32 v16, v0, v224
    v_or_b32 v17, v0, v228
    v_or_b32 v18, v0, v232
    v_or_b32 v19, v0, v236
    v_pk_max_u16 v20, v16, v17
    v_pk_min_u16 v21, v16, v17
    v_pk_max_u16 v22, v18, v19
    v_pk_min_u16 v23, v18, v19
    v_pk_min_u16 v20, v20, v22
    v_pk_max_u16 v21, v21, v23
    v_pk_max_u16 v20, v20, v21
    v_xor_b32 v20, v0, v20
    v_sub_u32 v16, v16, v20
    v_sub_u32 v17, v17, v20
    v_sub_u32 v18, v18, v20
    v_sub_u32 v19, v19, v20
    v_pk_ashrrev_i16 v16, 15, v16 op_sel_hi:[0,1]
    v_pk_ashrrev_i16 v17, 15, v17 op_sel_hi:[0,1]
    v_pk_ashrrev_i16 v18, 15, v18 op_sel_hi:[0,1]
    v_pk_ashrrev_i16 v19, 15, v19 op_sel_hi:[0,1]
    v_and_b32 v224, v16, v224
    v_and_b32 v228, v17, v228
    v_and_b32 v232, v18, v232
    v_and_b32 v236, v19, v236
    v_or_b32 v16, v0, v225
    v_or_b32 v17, v0, v229
    v_or_b32 v18, v0, v233
    v_or_b32 v19, v0, v237
    v_pk_max_u16 v20, v16, v17
    v_pk_min_u16 v21, v16, v17
    v_pk_max_u16 v22, v18, v19
    v_pk_min_u16 v23, v18, v19
    v_pk_min_u16 v20, v20, v22
    v_pk_max_u16 v21, v21, v23
    v_pk_max_u16 v20, v20, v21
    v_xor_b32 v20, v0, v20
    v_sub_u32 v16, v16, v20
    v_sub_u32 v17, v17, v20
    v_sub_u32 v18, v18, v20
    v_sub_u32 v19, v19, v20
    v_pk_ashrrev_i16 v16, 15, v16 op_sel_hi:[0,1]
    v_pk_ashrrev_i16 v17, 15, v17 op_sel_hi:[0,1]
    v_pk_ashrrev_i16 v18, 15, v18 op_sel_hi:[0,1]
    v_pk_ashrrev_i16 v19, 15, v19 op_sel_hi:[0,1]
    v_and_b32 v225, v16, v225
    v_and_b32 v229, v17, v229
    v_and_b32 v233, v18, v233
    v_and_b32 v237, v19, v237
    v_or_b32 v16, v0, v226
    v_or_b32 v17, v0, v230
    v_or_b32 v18, v0, v234
    v_or_b32 v19, v0, v238
    v_pk_max_u16 v20, v16, v17
    v_pk_min_u16 v21, v16, v17
    v_pk_max_u16 v22, v18, v19
    v_pk_min_u16 v23, v18, v19
    v_pk_min_u16 v20, v20, v22
    v_pk_max_u16 v21, v21, v23
    v_pk_max_u16 v20, v20, v21
    v_xor_b32 v20, v0, v20
    v_sub_u32 v16, v16, v20
    v_sub_u32 v17, v17, v20
    v_sub_u32 v18, v18, v20
    v_sub_u32 v19, v19, v20
    v_pk_ashrrev_i16 v16, 15, v16 op_sel_hi:[0,1]
    v_pk_ashrrev_i16 v17, 15, v17 op_sel_hi:[0,1]
    v_pk_ashrrev_i16 v18, 15, v18 op_sel_hi:[0,1]
    v_pk_ashrrev_i16 v19, 15, v19 op_sel_hi:[0,1]
    v_and_b32 v226, v16, v226
    v_and_b32 v230, v17, v230
    v_and_b32 v234, v18, v234
    v_and_b32 v238, v19, v238
    v_or_b32 v16, v0, v227
    v_or_b32 v17, v0, v231
    v_or_b32 v18, v0, v235
    v_or_b32 v19, v0, v239
    v_pk_max_u16 v20, v16, v17
    v_pk_min_u16 v21, v16, v17
    v_pk_max_u16 v22, v18, v19
    v_pk_min_u16 v23, v18, v19
    v_pk_min_u16 v20, v20, v22
    v_pk_max_u16 v21, v21, v23
    v_pk_max_u16 v20, v20, v21
    v_xor_b32 v20, v0, v20
    v_sub_u32 v16, v16, v20
    v_sub_u32 v17, v17, v20
    v_sub_u32 v18, v18, v20
    v_sub_u32 v19, v19, v20
    v_pk_ashrrev_i16 v16, 15, v16 op_sel_hi:[0,1]
    v_pk_ashrrev_i16 v17, 15, v17 op_sel_hi:[0,1]
    v_pk_ashrrev_i16 v18, 15, v18 op_sel_hi:[0,1]
    v_pk_ashrrev_i16 v19, 15, v19 op_sel_hi:[0,1]
    v_and_b32 v227, v16, v227
    v_and_b32 v231, v17, v231
    v_and_b32 v235, v18, v235
    v_and_b32 v239, v19, v239
    ds_write2_b64 v1, v[224:225], v[226:227] offset0:1 offset1:0
    ds_write2_b64 v2, v[228:229], v[230:231] offset0:33 offset1:32
    ds_write2_b64 v3, v[232:233], v[234:235] offset0:65 offset1:64
    ds_write2_b64 v4, v[236:237], v[238:239] offset0:97 offset1:96
    v_xor_b32 v35, 0x2000, v33
    buffer_load_dwordx4 v[64:67], v35, s[12:15], s43 offen offset:0
    buffer_load_dwordx4 v[68:71], v35, s[12:15], s43 offen offset:1024
    buffer_load_dwordx4 v[72:75], v35, s[12:15], s43 offen offset:2048
    buffer_load_dwordx4 v[76:79], v35, s[12:15], s43 offen offset:3072
    buffer_load_dwordx4 v[96:99], v33, s[12:15], s43 offen offset:0
    buffer_load_dwordx4 v[100:103], v33, s[12:15], s43 offen offset:1024
    buffer_load_dwordx4 v[104:107], v33, s[12:15], s43 offen offset:2048
    buffer_load_dwordx4 v[108:111], v33, s[12:15], s43 offen offset:3072
    s_waitcnt lgkmcnt(0)
    s_barrier
    s_waitcnt vmcnt(8)
    v_or_b32 v16, v0, v240
    v_or_b32 v17, v0, v244
    v_or_b32 v18, v0, v248
    v_or_b32 v19, v0, v252
    v_pk_max_u16 v20, v16, v17
    v_pk_min_u16 v21, v16, v17
    v_pk_max_u16 v22, v18, v19
    v_pk_min_u16 v23, v18, v19
    v_pk_min_u16 v20, v20, v22
    v_pk_max_u16 v21, v21, v23
    v_pk_max_u16 v20, v20, v21
    v_xor_b32 v20, v0, v20
    v_sub_u32 v16, v16, v20
    v_sub_u32 v17, v17, v20
    v_sub_u32 v18, v18, v20
    v_sub_u32 v19, v19, v20
    v_pk_ashrrev_i16 v16, 15, v16 op_sel_hi:[0,1]
    v_pk_ashrrev_i16 v17, 15, v17 op_sel_hi:[0,1]
    v_pk_ashrrev_i16 v18, 15, v18 op_sel_hi:[0,1]
    v_pk_ashrrev_i16 v19, 15, v19 op_sel_hi:[0,1]
    v_and_b32 v240, v16, v240
    v_and_b32 v244, v17, v244
    v_and_b32 v248, v18, v248
    v_and_b32 v252, v19, v252
    v_or_b32 v16, v0, v241
    v_or_b32 v17, v0, v245
    v_or_b32 v18, v0, v249
    v_or_b32 v19, v0, v253
    v_pk_max_u16 v20, v16, v17
    v_pk_min_u16 v21, v16, v17
    v_pk_max_u16 v22, v18, v19
    v_pk_min_u16 v23, v18, v19
    v_pk_min_u16 v20, v20, v22
    v_pk_max_u16 v21, v21, v23
    v_pk_max_u16 v20, v20, v21
    v_xor_b32 v20, v0, v20
    v_sub_u32 v16, v16, v20
    v_sub_u32 v17, v17, v20
    v_sub_u32 v18, v18, v20
    v_sub_u32 v19, v19, v20
    v_pk_ashrrev_i16 v16, 15, v16 op_sel_hi:[0,1]
    v_pk_ashrrev_i16 v17, 15, v17 op_sel_hi:[0,1]
    v_pk_ashrrev_i16 v18, 15, v18 op_sel_hi:[0,1]
    v_pk_ashrrev_i16 v19, 15, v19 op_sel_hi:[0,1]
    v_and_b32 v241, v16, v241
    v_and_b32 v245, v17, v245
    v_and_b32 v249, v18, v249
    v_and_b32 v253, v19, v253
    v_or_b32 v16, v0, v242
    v_or_b32 v17, v0, v246
    v_or_b32 v18, v0, v250
    v_or_b32 v19, v0, v254
    v_pk_max_u16 v20, v16, v17
    v_pk_min_u16 v21, v16, v17
    v_pk_max_u16 v22, v18, v19
    v_pk_min_u16 v23, v18, v19
    v_pk_min_u16 v20, v20, v22
    v_pk_max_u16 v21, v21, v23
    v_pk_max_u16 v20, v20, v21
    v_xor_b32 v20, v0, v20
    v_sub_u32 v16, v16, v20
    v_sub_u32 v17, v17, v20
    v_sub_u32 v18, v18, v20
    v_sub_u32 v19, v19, v20
    v_pk_ashrrev_i16 v16, 15, v16 op_sel_hi:[0,1]
    v_pk_ashrrev_i16 v17, 15, v17 op_sel_hi:[0,1]
    v_pk_ashrrev_i16 v18, 15, v18 op_sel_hi:[0,1]
    v_pk_ashrrev_i16 v19, 15, v19 op_sel_hi:[0,1]
    v_and_b32 v242, v16, v242
    v_and_b32 v246, v17, v246
    v_and_b32 v250, v18, v250
    v_and_b32 v254, v19, v254
    v_or_b32 v16, v0, v243
    v_or_b32 v17, v0, v247
    v_or_b32 v18, v0, v251
    v_or_b32 v19, v0, v255
    v_pk_max_u16 v20, v16, v17
    v_pk_min_u16 v21, v16, v17
    v_pk_max_u16 v22, v18, v19
    v_pk_min_u16 v23, v18, v19
    v_pk_min_u16 v20, v20, v22
    v_pk_max_u16 v21, v21, v23
    v_pk_max_u16 v20, v20, v21
    v_xor_b32 v20, v0, v20
    v_sub_u32 v16, v16, v20
    v_sub_u32 v17, v17, v20
    v_sub_u32 v18, v18, v20
    v_sub_u32 v19, v19, v20
    v_pk_ashrrev_i16 v16, 15, v16 op_sel_hi:[0,1]
    v_pk_ashrrev_i16 v17, 15, v17 op_sel_hi:[0,1]
    v_pk_ashrrev_i16 v18, 15, v18 op_sel_hi:[0,1]
    v_pk_ashrrev_i16 v19, 15, v19 op_sel_hi:[0,1]
    v_and_b32 v243, v16, v243
    v_and_b32 v247, v17, v247
    v_and_b32 v251, v18, v251
    v_and_b32 v255, v19, v255
    v_add_u32 v1, 0x8000, v1
    v_add_u32 v2, 0x8000, v2
    v_add_u32 v3, 0x8000, v3
    v_add_u32 v4, 0x8000, v4
    ds_write2_b64 v1, v[240:241], v[242:243] offset0:1 offset1:0
    ds_write2_b64 v2, v[244:245], v[246:247] offset0:33 offset1:32
    ds_write2_b64 v3, v[248:249], v[250:251] offset0:65 offset1:64
    ds_write2_b64 v4, v[252:253], v[254:255] offset0:97 offset1:96
    s_add_u32 m0, s28, 0x4000
    s_add_u32 s4, s32, 0x4000
    buffer_load_dwordx4 v12, s[8:11], s4 offen offset:0  lds
    buffer_load_dwordx4 v13, s[8:11], s4 offen offset:1024  lds
    buffer_load_dwordx4 v14, s[8:11], s4 offen offset:2048  lds
    buffer_load_dwordx4 v15, s[8:11], s4 offen offset:3072  lds
    s_waitcnt lgkmcnt(0)
    s_barrier
    s_waitcnt vmcnt(8)
    v_or_b32 v16, v0, v64
    v_or_b32 v17, v0, v68
    v_or_b32 v18, v0, v72
    v_or_b32 v19, v0, v76
    v_pk_max_u16 v20, v16, v17
    v_pk_min_u16 v21, v16, v17
    v_pk_max_u16 v22, v18, v19
    v_pk_min_u16 v23, v18, v19
    v_pk_min_u16 v20, v20, v22
    v_pk_max_u16 v21, v21, v23
    v_pk_max_u16 v20, v20, v21
    v_xor_b32 v20, v0, v20
    v_sub_u32 v16, v16, v20
    v_sub_u32 v17, v17, v20
    v_sub_u32 v18, v18, v20
    v_sub_u32 v19, v19, v20
    v_pk_ashrrev_i16 v16, 15, v16 op_sel_hi:[0,1]
    v_pk_ashrrev_i16 v17, 15, v17 op_sel_hi:[0,1]
    v_pk_ashrrev_i16 v18, 15, v18 op_sel_hi:[0,1]
    v_pk_ashrrev_i16 v19, 15, v19 op_sel_hi:[0,1]
    v_and_b32 v64, v16, v64
    v_and_b32 v68, v17, v68
    v_and_b32 v72, v18, v72
    v_and_b32 v76, v19, v76
    v_or_b32 v16, v0, v65
    v_or_b32 v17, v0, v69
    v_or_b32 v18, v0, v73
    v_or_b32 v19, v0, v77
    v_pk_max_u16 v20, v16, v17
    v_pk_min_u16 v21, v16, v17
    v_pk_max_u16 v22, v18, v19
    v_pk_min_u16 v23, v18, v19
    v_pk_min_u16 v20, v20, v22
    v_pk_max_u16 v21, v21, v23
    v_pk_max_u16 v20, v20, v21
    v_xor_b32 v20, v0, v20
    v_sub_u32 v16, v16, v20
    v_sub_u32 v17, v17, v20
    v_sub_u32 v18, v18, v20
    v_sub_u32 v19, v19, v20
    v_pk_ashrrev_i16 v16, 15, v16 op_sel_hi:[0,1]
    v_pk_ashrrev_i16 v17, 15, v17 op_sel_hi:[0,1]
    v_pk_ashrrev_i16 v18, 15, v18 op_sel_hi:[0,1]
    v_pk_ashrrev_i16 v19, 15, v19 op_sel_hi:[0,1]
    v_and_b32 v65, v16, v65
    v_and_b32 v69, v17, v69
    v_and_b32 v73, v18, v73
    v_and_b32 v77, v19, v77
    v_or_b32 v16, v0, v66
    v_or_b32 v17, v0, v70
    v_or_b32 v18, v0, v74
    v_or_b32 v19, v0, v78
    v_pk_max_u16 v20, v16, v17
    v_pk_min_u16 v21, v16, v17
    v_pk_max_u16 v22, v18, v19
    v_pk_min_u16 v23, v18, v19
    v_pk_min_u16 v20, v20, v22
    v_pk_max_u16 v21, v21, v23
    v_pk_max_u16 v20, v20, v21
    v_xor_b32 v20, v0, v20
    v_sub_u32 v16, v16, v20
    v_sub_u32 v17, v17, v20
    v_sub_u32 v18, v18, v20
    v_sub_u32 v19, v19, v20
    v_pk_ashrrev_i16 v16, 15, v16 op_sel_hi:[0,1]
    v_pk_ashrrev_i16 v17, 15, v17 op_sel_hi:[0,1]
    v_pk_ashrrev_i16 v18, 15, v18 op_sel_hi:[0,1]
    v_pk_ashrrev_i16 v19, 15, v19 op_sel_hi:[0,1]
    v_and_b32 v66, v16, v66
    v_and_b32 v70, v17, v70
    v_and_b32 v74, v18, v74
    v_and_b32 v78, v19, v78
    v_or_b32 v16, v0, v67
    v_or_b32 v17, v0, v71
    v_or_b32 v18, v0, v75
    v_or_b32 v19, v0, v79
    v_pk_max_u16 v20, v16, v17
    v_pk_min_u16 v21, v16, v17
    v_pk_max_u16 v22, v18, v19
    v_pk_min_u16 v23, v18, v19
    v_pk_min_u16 v20, v20, v22
    v_pk_max_u16 v21, v21, v23
    v_pk_max_u16 v20, v20, v21
    v_xor_b32 v20, v0, v20
    v_sub_u32 v16, v16, v20
    v_sub_u32 v17, v17, v20
    v_sub_u32 v18, v18, v20
    v_sub_u32 v19, v19, v20
    v_pk_ashrrev_i16 v16, 15, v16 op_sel_hi:[0,1]
    v_pk_ashrrev_i16 v17, 15, v17 op_sel_hi:[0,1]
    v_pk_ashrrev_i16 v18, 15, v18 op_sel_hi:[0,1]
    v_pk_ashrrev_i16 v19, 15, v19 op_sel_hi:[0,1]
    v_and_b32 v67, v16, v67
    v_and_b32 v71, v17, v71
    v_and_b32 v75, v18, v75
    v_and_b32 v79, v19, v79
    s_barrier
    v_subrev_u32 v1, 0x800, v1
    v_subrev_u32 v2, 0x800, v2
    v_subrev_u32 v3, 0x800, v3
    v_subrev_u32 v4, 0x800, v4
    ds_write_b128 v1, v[64:67] offset:0
    ds_write_b128 v2, v[68:71] offset:256
    ds_write_b128 v3, v[72:75] offset:512
    ds_write_b128 v4, v[76:79] offset:768
    s_add_u32 m0, s28, 0xc000
    s_add_u32 s4, s33, 0x4000
    buffer_load_dwordx4 v12, s[8:11], s4 offen offset:0  lds
    buffer_load_dwordx4 v13, s[8:11], s4 offen offset:1024  lds
    buffer_load_dwordx4 v14, s[8:11], s4 offen offset:2048  lds
    buffer_load_dwordx4 v15, s[8:11], s4 offen offset:3072  lds
    s_waitcnt vmcnt(8)
    v_or_b32 v16, v0, v96
    v_or_b32 v17, v0, v100
    v_or_b32 v18, v0, v104
    v_or_b32 v19, v0, v108
    v_pk_max_u16 v20, v16, v17
    v_pk_min_u16 v21, v16, v17
    v_pk_max_u16 v22, v18, v19
    v_pk_min_u16 v23, v18, v19
    v_pk_min_u16 v20, v20, v22
    v_pk_max_u16 v21, v21, v23
    v_pk_max_u16 v20, v20, v21
    v_xor_b32 v20, v0, v20
    v_sub_u32 v16, v16, v20
    v_sub_u32 v17, v17, v20
    v_sub_u32 v18, v18, v20
    v_sub_u32 v19, v19, v20
    v_pk_ashrrev_i16 v16, 15, v16 op_sel_hi:[0,1]
    v_pk_ashrrev_i16 v17, 15, v17 op_sel_hi:[0,1]
    v_pk_ashrrev_i16 v18, 15, v18 op_sel_hi:[0,1]
    v_pk_ashrrev_i16 v19, 15, v19 op_sel_hi:[0,1]
    v_and_b32 v96, v16, v96
    v_and_b32 v100, v17, v100
    v_and_b32 v104, v18, v104
    v_and_b32 v108, v19, v108
    v_or_b32 v16, v0, v97
    v_or_b32 v17, v0, v101
    v_or_b32 v18, v0, v105
    v_or_b32 v19, v0, v109
    v_pk_max_u16 v20, v16, v17
    v_pk_min_u16 v21, v16, v17
    v_pk_max_u16 v22, v18, v19
    v_pk_min_u16 v23, v18, v19
    v_pk_min_u16 v20, v20, v22
    v_pk_max_u16 v21, v21, v23
    v_pk_max_u16 v20, v20, v21
    v_xor_b32 v20, v0, v20
    v_sub_u32 v16, v16, v20
    v_sub_u32 v17, v17, v20
    v_sub_u32 v18, v18, v20
    v_sub_u32 v19, v19, v20
    v_pk_ashrrev_i16 v16, 15, v16 op_sel_hi:[0,1]
    v_pk_ashrrev_i16 v17, 15, v17 op_sel_hi:[0,1]
    v_pk_ashrrev_i16 v18, 15, v18 op_sel_hi:[0,1]
    v_pk_ashrrev_i16 v19, 15, v19 op_sel_hi:[0,1]
    v_and_b32 v97, v16, v97
    v_and_b32 v101, v17, v101
    v_and_b32 v105, v18, v105
    v_and_b32 v109, v19, v109
    v_or_b32 v16, v0, v98
    v_or_b32 v17, v0, v102
    v_or_b32 v18, v0, v106
    v_or_b32 v19, v0, v110
    v_pk_max_u16 v20, v16, v17
    v_pk_min_u16 v21, v16, v17
    v_pk_max_u16 v22, v18, v19
    v_pk_min_u16 v23, v18, v19
    v_pk_min_u16 v20, v20, v22
    v_pk_max_u16 v21, v21, v23
    v_pk_max_u16 v20, v20, v21
    v_xor_b32 v20, v0, v20
    v_sub_u32 v16, v16, v20
    v_sub_u32 v17, v17, v20
    v_sub_u32 v18, v18, v20
    v_sub_u32 v19, v19, v20
    s_waitcnt vmcnt(4)
    s_barrier
    s_setprio 0
    v_pk_ashrrev_i16 v16, 15, v16 op_sel_hi:[0,1]
    v_pk_ashrrev_i16 v17, 15, v17 op_sel_hi:[0,1]
    v_pk_ashrrev_i16 v18, 15, v18 op_sel_hi:[0,1]
    v_pk_ashrrev_i16 v19, 15, v19 op_sel_hi:[0,1]
    v_and_b32 v98, v16, v98
    v_and_b32 v102, v17, v102
    v_and_b32 v106, v18, v106
    v_and_b32 v110, v19, v110
    v_or_b32 v16, v0, v99
    v_or_b32 v17, v0, v103
    v_or_b32 v18, v0, v107
    v_or_b32 v19, v0, v111
    v_pk_max_u16 v20, v16, v17
    v_pk_min_u16 v21, v16, v17
    v_pk_max_u16 v22, v18, v19
    v_pk_min_u16 v23, v18, v19
    v_pk_min_u16 v20, v20, v22
    v_pk_max_u16 v21, v21, v23
    v_pk_max_u16 v20, v20, v21
    v_xor_b32 v20, v0, v20
    v_sub_u32 v16, v16, v20
    v_sub_u32 v17, v17, v20
    v_sub_u32 v18, v18, v20
    v_sub_u32 v19, v19, v20
    v_pk_ashrrev_i16 v16, 15, v16 op_sel_hi:[0,1]
    v_pk_ashrrev_i16 v17, 15, v17 op_sel_hi:[0,1]
    v_pk_ashrrev_i16 v18, 15, v18 op_sel_hi:[0,1]
    v_pk_ashrrev_i16 v19, 15, v19 op_sel_hi:[0,1]
    v_and_b32 v99, v16, v99
    v_and_b32 v103, v17, v103
    v_and_b32 v107, v18, v107
    v_and_b32 v111, v19, v111
    s_setprio 3
    v_add_u32 v1, 0x800, v1
    v_add_u32 v2, 0x800, v2
    v_add_u32 v3, 0x800, v3
    v_add_u32 v4, 0x800, v4
    ds_write2_b64 v1, v[96:97], v[98:99] offset0:1 offset1:0
    ds_write2_b64 v2, v[100:101], v[102:103] offset0:33 offset1:32
    ds_write2_b64 v3, v[104:105], v[106:107] offset0:65 offset1:64
    ds_write2_b64 v4, v[108:109], v[110:111] offset0:97 offset1:96
    s_setprio 0
    s_add_u32 m0, s28, 0x10000
    s_nop 0
    buffer_load_dwordx4 v12, s[8:11], s34 offen offset:0  lds
    buffer_load_dwordx4 v13, s[8:11], s34 offen offset:1024  lds
    buffer_load_dwordx4 v14, s[8:11], s34 offen offset:2048  lds
    buffer_load_dwordx4 v15, s[8:11], s34 offen offset:3072  lds
    s_add_u32 m0, s28, 0x14000
    s_add_u32 s4, s34, 0x4000
    buffer_load_dwordx4 v12, s[8:11], s4 offen offset:0  lds
    buffer_load_dwordx4 v13, s[8:11], s4 offen offset:1024  lds
    buffer_load_dwordx4 v14, s[8:11], s4 offen offset:2048  lds
    buffer_load_dwordx4 v15, s[8:11], s4 offen offset:3072  lds
    s_waitcnt vmcnt(8)
    s_barrier
    s_add_u32 m0, s28, 0x18000
    s_nop 0
    buffer_load_dwordx4 v12, s[8:11], s35 offen offset:0  lds
    buffer_load_dwordx4 v13, s[8:11], s35 offen offset:1024  lds
    buffer_load_dwordx4 v14, s[8:11], s35 offen offset:2048  lds
    buffer_load_dwordx4 v15, s[8:11], s35 offen offset:3072  lds
    s_add_u32 m0, s28, 0x1c000
    s_add_u32 s4, s35, 0x4000
    buffer_load_dwordx4 v12, s[8:11], s4 offen offset:0  lds
    buffer_load_dwordx4 v13, s[8:11], s4 offen offset:1024  lds
    buffer_load_dwordx4 v14, s[8:11], s4 offen offset:2048  lds
    buffer_load_dwordx4 v15, s[8:11], s4 offen offset:3072  lds
    s_waitcnt lgkmcnt(0)
    s_barrier
    s_waitcnt vmcnt(8)
    s_barrier
    s_barrier
    s_add_u32 m0, s28, 0x20000
    s_nop 0
    buffer_load_dwordx4 v12, s[8:11], s36 offen offset:0  lds
    s_waitcnt vmcnt(3)
    buffer_load_dwordx4 v13, s[8:11], s36 offen offset:1024  lds
    s_waitcnt vmcnt(3)
    buffer_load_dwordx4 v14, s[8:11], s36 offen offset:2048  lds
    s_waitcnt vmcnt(3)
    buffer_load_dwordx4 v15, s[8:11], s36 offen offset:3072  lds
    s_waitcnt vmcnt(3)
    s_add_u32 m0, s28, 0x24000
    s_add_u32 s4, s36, 0x4000
    buffer_load_dwordx4 v12, s[8:11], s4 offen offset:0  lds
    s_waitcnt vmcnt(3)
    buffer_load_dwordx4 v13, s[8:11], s4 offen offset:1024  lds
    s_waitcnt vmcnt(3)
    buffer_load_dwordx4 v14, s[8:11], s4 offen offset:2048  lds
    s_waitcnt vmcnt(3)
    buffer_load_dwordx4 v15, s[8:11], s4 offen offset:3072  lds
    s_waitcnt vmcnt(3)
    s_barrier
    s_add_u32 m0, s28, 0x0
    s_nop 0
    buffer_load_dwordx4 v12, s[8:11], s37 offen offset:0  lds
    s_waitcnt vmcnt(3)
    buffer_load_dwordx4 v13, s[8:11], s37 offen offset:1024  lds
    s_waitcnt vmcnt(3)
    buffer_load_dwordx4 v14, s[8:11], s37 offen offset:2048  lds
    s_waitcnt vmcnt(3)
    buffer_load_dwordx4 v15, s[8:11], s37 offen offset:3072  lds
    s_waitcnt vmcnt(3)
    s_add_u32 m0, s28, 0x4000
    s_add_u32 s4, s37, 0x4000
    buffer_load_dwordx4 v12, s[8:11], s4 offen offset:0  lds
    s_waitcnt vmcnt(3)
    buffer_load_dwordx4 v13, s[8:11], s4 offen offset:1024  lds
    s_waitcnt vmcnt(3)
    buffer_load_dwordx4 v14, s[8:11], s4 offen offset:2048  lds
    s_waitcnt vmcnt(3)
    buffer_load_dwordx4 v15, s[8:11], s4 offen offset:3072  lds
    s_waitcnt vmcnt(3)
    s_barrier
    s_add_u32 m0, s28, 0x8000
    s_nop 0
    buffer_load_dwordx4 v12, s[8:11], s38 offen offset:0  lds
    s_waitcnt vmcnt(3)
    buffer_load_dwordx4 v13, s[8:11], s38 offen offset:1024  lds
    s_waitcnt vmcnt(3)
    buffer_load_dwordx4 v14, s[8:11], s38 offen offset:2048  lds
    s_waitcnt vmcnt(3)
    buffer_load_dwordx4 v15, s[8:11], s38 offen offset:3072  lds
    s_waitcnt vmcnt(3)
    s_add_u32 m0, s28, 0xc000
    s_add_u32 s4, s38, 0x4000
    buffer_load_dwordx4 v12, s[8:11], s4 offen offset:0  lds
    s_waitcnt vmcnt(3)
    buffer_load_dwordx4 v13, s[8:11], s4 offen offset:1024  lds
    s_waitcnt vmcnt(3)
    buffer_load_dwordx4 v14, s[8:11], s4 offen offset:2048  lds
    s_waitcnt vmcnt(3)
    buffer_load_dwordx4 v15, s[8:11], s4 offen offset:3072  lds
    s_waitcnt vmcnt(3)
    s_barrier
    s_add_u32 m0, s28, 0x10000
    s_nop 0
    buffer_load_dwordx4 v12, s[8:11], s39 offen offset:0  lds
    s_waitcnt vmcnt(3)
    buffer_load_dwordx4 v13, s[8:11], s39 offen offset:1024  lds
    s_waitcnt vmcnt(3)
    buffer_load_dwordx4 v14, s[8:11], s39 offen offset:2048  lds
    s_waitcnt vmcnt(3)
    buffer_load_dwordx4 v15, s[8:11], s39 offen offset:3072  lds
    s_waitcnt vmcnt(3)
    s_add_u32 m0, s28, 0x14000
    s_add_u32 s4, s39, 0x4000
    buffer_load_dwordx4 v12, s[8:11], s4 offen offset:0  lds
    s_waitcnt vmcnt(3)
    buffer_load_dwordx4 v13, s[8:11], s4 offen offset:1024  lds
    s_waitcnt vmcnt(3)
    buffer_load_dwordx4 v14, s[8:11], s4 offen offset:2048  lds
    s_waitcnt vmcnt(3)
    buffer_load_dwordx4 v15, s[8:11], s4 offen offset:3072  lds
    s_waitcnt vmcnt(3)
    s_barrier
    s_waitcnt vmcnt(0)
    s_barrier
L_end:
    s_endpgm
.section .rodata,"a"
.p2align 6
.amdhsa_kernel standalone__structured_sparse_n_m__ragged_kernel
  .amdhsa_next_free_vgpr 256
  .amdhsa_next_free_sgpr 48
  .amdhsa_accum_offset 256
  .amdhsa_group_segment_fixed_size 0
  .amdhsa_kernarg_size 48
  .amdhsa_user_sgpr_count 2
  .amdhsa_user_sgpr_kernarg_segment_ptr 1
  .amdhsa_system_sgpr_workgroup_id_x 1
.end_amdhsa_kernel
```
